```python
import torch

def _softmax(x, axis=-1):
    return torch.softmax(x, dim=axis)
def _gelu(x):
    return torch.nn.functional.gelu(x, approximate="tanh")
def _silu(x):
    return torch.nn.functional.silu(x)
def _sigmoid(x):
    return torch.sigmoid(x)
def _layernorm(x, axis=-1, eps=1e-5):
    m = x.mean(dim=axis, keepdim=True)
    v = x.var(dim=axis, keepdim=True, unbiased=False)
    return (x - m) / torch.sqrt(v + eps)
def _scatter_add(tgt, idx, src, axis=0):
    return tgt.clone().index_add_(axis, idx, src)
def _segment_sum(src, seg, n):
    out = torch.zeros((n,) + src.shape[1:], dtype=src.dtype)
    return out.index_add_(0, seg, src)
def _pad(x, pw):
    flat = tuple(v for pair in reversed(pw) for v in pair)
    return torch.nn.functional.pad(x, flat)

kernel_name = 'gated_mix__grouped_kv_mqa__moe_arch_mod__prompt'

def setup_inputs():

    _w = (lambda a: (lambda t: t.to(torch.bfloat16) if t.is_floating_point() else t)(torch.as_tensor(a)))
    def _A_setup():
        B, S, D, H = 1, 2048, 1024, 32
        Dh = D // H
        return {
            "x": _w((lambda *s: torch.randn(*s, dtype=torch.bfloat16) * 0.05)(B, S, D)),
            "wq": _w((lambda *s: torch.randn(*s, dtype=torch.bfloat16) * 0.8)(D, H * Dh)),
            "wk": _w((lambda *s: torch.randn(*s, dtype=torch.bfloat16) * 0.8)(D, Dh)),
            "wv": _w((lambda *s: torch.randn(*s, dtype=torch.bfloat16) * 0.1)(D, Dh)),
            "wo": _w((lambda *s: torch.randn(*s, dtype=torch.bfloat16) * 0.1)(H * Dh, D)),
        }
    _A_in = _A_setup()

    def _B_setup():
        B, S, D, F, C = 1, 2048, 1024, 3584, 8
        return {
            "x": _w((lambda *s: torch.randn(*s, dtype=torch.bfloat16) * 0.05)(B, S, D)),
            "w_r": _w((lambda *s: torch.randn(*s, dtype=torch.bfloat16) * 1.6)(D)),
            "w_gate": _w((lambda *s: torch.randn(*s, dtype=torch.bfloat16) * 0.1)(D, F)),
            "w_up": _w((lambda *s: torch.randn(*s, dtype=torch.bfloat16) * 0.1)(D, F)),
            "w_down": _w((lambda *s: torch.randn(*s, dtype=torch.bfloat16) * 0.1)(F, D)),
        }
    _B_in = _B_setup()

    return {
        "A_x": _A_in["x"],
        "A_wq": _A_in["wq"],
        "A_wk": _A_in["wk"],
        "A_wv": _A_in["wv"],
        "A_wo": _A_in["wo"],
        "B_x": _B_in["x"],
        "B_w_r": _B_in["w_r"],
        "B_w_gate": _B_in["w_gate"],
        "B_w_up": _B_in["w_up"],
        "B_w_down": _B_in["w_down"],
        "gate_w": _w((lambda *s: torch.randn(*s, dtype=torch.bfloat16) * 0.05)(1024) * 16.0),
    }

def reference(A_x, A_wq, A_wk, A_wv, A_wo, B_x, B_w_r, B_w_gate, B_w_up, B_w_down, gate_w):
    def _A_ref(x, wq, wk, wv, wo):
        B, S, D = x.shape
        H = 32
        Dh = D // H
        q = (lambda x, *d: x.permute(*d))((x @ wq).reshape(B, S, H, Dh), 0, 2, 1, 3)
        k = x @ wk
        v = x @ wv
        scores = torch.einsum("bhqd,bkd->bhqk", q, k) * (Dh ** -0.5)
        p = _softmax(scores, axis=-1)
        o = torch.einsum("bhqk,bkd->bhqd", p, v)
        return (lambda x, *d: x.permute(*d))(o, 0, 2, 1, 3).reshape(B, S, H * Dh) @ wo

    def _B_ref(x, w_r, w_gate, w_up, w_down):
        B, S, D = x.shape
        C = 8
        r = x @ w_r
        idx = torch.argsort(-r, axis=-1)[:, :C]
        idx_e = (lambda x, n, axis: torch.repeat_interleave(x, n, dim=axis))(idx.reshape(B, C, 1), D, axis=2)
        x_sel = (lambda x, i, axis: torch.take_along_dim(x, i, dim=axis))(x, idx_e, axis=1)
        g = _silu(x_sel @ w_gate)
        u = x_sel @ w_up
        y = (g * u) @ w_down
        r_sel = _sigmoid((lambda x, i, axis: torch.take_along_dim(x, i, dim=axis))(r, idx, axis=1))
        y = y * r_sel.reshape(B, C, 1)
        b_off = (torch.arange(B) * S).reshape(B, 1)
        flat_idx = (idx + b_off).reshape(B * C)
        zero = (x * 0.0).reshape(B * S, D)
        upd = _scatter_add(zero, flat_idx, y.reshape(B * C, D), axis=0)
        return x + upd.reshape(B, S, D)

    x = A_x
    g = _sigmoid((x * gate_w).sum(-1, keepdims=True))
    a = _A_ref(x, A_wq, A_wk, A_wv, A_wo)
    b = _B_ref(x, B_w_r, B_w_gate, B_w_up, B_w_down)
    return g * a + (1 - g) * b
```

```asm
; @launch grid=(256,1,1) block=(768,1,1) lds=163840
.amdgcn_target "amdgcn-amd-amdhsa--gfx950"
.text
.globl gated_mix__grouped_kv_mqa__moe_arch_mod__prompt_kernel
.p2align 8
.type gated_mix__grouped_kv_mqa__moe_arch_mod__prompt_kernel,@function
gated_mix__grouped_kv_mqa__moe_arch_mod__prompt_kernel:
    s_cmp_ge_u32 s2, 256
    s_cbranch_scc1 L_END
    s_load_dwordx2 s[8:9], s[0:1], 0
    s_load_dwordx2 s[12:13], s[0:1], 8
    s_load_dwordx4 s[56:59], s[0:1], 16
    s_load_dwordx2 s[20:21], s[0:1], 104
    s_load_dwordx2 s[24:25], s[0:1], 32
    s_load_dwordx2 s[28:29], s[0:1], 88
    s_load_dwordx2 s[32:33], s[0:1], 56
    s_load_dwordx2 s[36:37], s[0:1], 64
    s_load_dwordx2 s[40:41], s[0:1], 72
    s_load_dwordx2 s[44:45], s[0:1], 48
    s_load_dwordx2 s[48:49], s[0:1], 80
    v_lshrrev_b32 v1, 6, v0
    v_and_b32 v0, 63, v0
    v_readfirstlane_b32 s3, v1
    s_and_b32 s6, s2, 1
    s_bfe_u32 s7, s2, 0x20003
    s_lshl_b32 s5, s6, 2
    s_add_u32 s5, s5, s7
    s_bfe_u32 s4, s2, 0x20001
    s_lshl_b32 s4, s4, 3
    s_lshr_b32 s53, s2, 5
    s_add_u32 s4, s4, s53
    s_mov_b32 s78, s7
    s_cmp_lg_u32 s78, 3
    s_cbranch_scc1 L_NOPF
    s_cmp_lg_u32 s3, 8
    s_cbranch_scc1 L_NOPF
    s_getpc_b64 s[60:61]
L_PC:
    s_sub_u32 s60, s60, L_PC-gated_mix__grouped_kv_mqa__moe_arch_mod__prompt_kernel
    s_subb_u32 s61, s61, 0
    s_and_b32 s62, s4, 7
    v_lshl_add_u32 v1, v0, 3, s62
    v_lshlrev_b32 v1, 7, v1
    v_min_u32 v1, L_CODE_END-gated_mix__grouped_kv_mqa__moe_arch_mod__prompt_kernel-4, v1
    global_load_dword v120, v1, s[60:61]
L_NOPF:
    s_mov_b32 s10, 0x400000
    s_mov_b32 s11, 0x20000
    s_mov_b32 s14, 0x200000
    s_mov_b32 s15, 0x20000
    s_mov_b32 s18, 0x10000
    s_mov_b32 s19, 0x20000
    s_mov_b32 s22, 0x1000000
    s_mov_b32 s23, 0x20000
    s_mov_b32 s26, 0x200000
    s_mov_b32 s27, 0x20000
    s_mov_b32 s30, 0x400000
    s_mov_b32 s31, 0x20000
    s_mov_b32 s34, 0x700000
    s_mov_b32 s35, 0x20000
    s_mov_b32 s38, 0x700000
    s_mov_b32 s39, 0x20000
    s_mov_b32 s42, 0x700000
    s_mov_b32 s43, 0x20000
    s_mov_b32 s46, 0x800
    s_mov_b32 s47, 0x20000
    s_mov_b32 s50, 0x800
    s_mov_b32 s51, 0x20000
    v_lshlrev_b32 v2, 4, v0
    s_add_u32 s54, s4, s78
    s_lshl_b32 s54, s54, 2
    s_lshr_b32 s53, s4, 3
    s_lshl_b32 s53, s53, 1
    s_add_u32 s54, s54, s53
    s_and_b32 s54, s54, 15
    s_waitcnt lgkmcnt(0)
    s_cmp_eq_u32 s7, 0
    s_cselect_b32 s16, s56, s58
    s_cselect_b32 s17, s57, s59
    s_add_u32 s56, s20, 8673280
    s_addc_u32 s57, s21, 0
    s_load_dword s52, s[56:57], 0
    s_cmp_ge_u32 s3, 8
    s_cbranch_scc1 H_START
    s_and_b32 s55, s3, 1
    s_lshr_b32 s56, s3, 1
    s_lshr_b32 s74, s3, 2
    s_and_b32 s75, s3, 3
    s_lshl_b32 s62, s75, 14
    s_lshr_b32 s73, s54, 1
    s_lshl_b32 s60, s75, 1
    s_add_u32 s73, s73, s60
    s_cmp_eq_u32 s74, 1
    s_cbranch_scc1 C_F1X
    s_cmp_eq_u32 s7, 3
    s_cbranch_scc1 C_F1LD
    s_cmp_eq_u32 s7, 2
    s_cbranch_scc1 C_F1RG
    s_add_u32 s60, s73, 0
    s_and_b32 s60, s60, 7
    s_lshl_b32 s61, s60, 13
    s_add_u32 m0, s62, 65536
    s_nop 0
    buffer_load_dwordx4 v2, s[16:19], s61 offen offset:0 lds
    buffer_load_dwordx4 v2, s[16:19], s61 offen offset:1024 lds
    buffer_load_dwordx4 v2, s[16:19], s61 offen offset:2048 lds
    buffer_load_dwordx4 v2, s[16:19], s61 offen offset:3072 lds
    s_add_u32 m0, m0, 4096
    s_add_u32 s61, s61, 4096
    buffer_load_dwordx4 v2, s[16:19], s61 offen offset:0 lds
    buffer_load_dwordx4 v2, s[16:19], s61 offen offset:1024 lds
    buffer_load_dwordx4 v2, s[16:19], s61 offen offset:2048 lds
    buffer_load_dwordx4 v2, s[16:19], s61 offen offset:3072 lds
    s_add_u32 s60, s73, 1
    s_and_b32 s60, s60, 7
    s_lshl_b32 s61, s60, 13
    s_add_u32 m0, s62, 73728
    s_nop 0
    buffer_load_dwordx4 v2, s[16:19], s61 offen offset:0 lds
    buffer_load_dwordx4 v2, s[16:19], s61 offen offset:1024 lds
    buffer_load_dwordx4 v2, s[16:19], s61 offen offset:2048 lds
    buffer_load_dwordx4 v2, s[16:19], s61 offen offset:3072 lds
    s_add_u32 m0, m0, 4096
    s_add_u32 s61, s61, 4096
    buffer_load_dwordx4 v2, s[16:19], s61 offen offset:0 lds
    buffer_load_dwordx4 v2, s[16:19], s61 offen offset:1024 lds
    buffer_load_dwordx4 v2, s[16:19], s61 offen offset:2048 lds
    buffer_load_dwordx4 v2, s[16:19], s61 offen offset:3072 lds
    s_branch C_F1LD
C_F1RG:
    s_lshl_b32 s57, s73, 8
    v_add_u32 v6, s57, v2
    v_and_b32 v6, 2047, v6
    v_mov_b32 v7, 0x40000000
    v_cmp_gt_u32 vcc, 32, v0
    s_nop 1
    v_cndmask_b32 v6, v7, v6, vcc
    s_add_u32 m0, s62, 65536
    s_nop 0
    buffer_load_dwordx4 v6, s[44:47], 0 offen lds
    s_add_u32 m0, s62, 66560
    s_nop 0
    buffer_load_dwordx4 v6, s[48:51], 0 offen lds
    s_branch C_F1LD
C_F1X:
    v_lshrrev_b32 v3, 4, v0
    v_and_b32 v4, 15, v0
    v_xor_b32 v4, v4, v3
    v_lshlrev_b32 v4, 4, v4
    v_lshl_add_u32 v5, v3, 11, v4
    s_lshl_b32 s57, s4, 1
    s_add_u32 s57, s57, s6
    s_lshl_b32 s57, s57, 16
    s_add_u32 s58, s73, 1
    s_and_b32 s58, s58, 7
    s_and_b32 s60, s73, 7
    s_sub_u32 s58, s58, s60
    s_lshl_b32 s58, s58, 8
    s_lshl_b32 s60, s60, 8
    s_add_u32 s57, s57, s60
    s_lshl_b32 s59, s78, 1
    s_add_u32 s60, s59, 0
    s_and_b32 s60, s60, 7
    s_lshl_b32 s61, s60, 10
    s_add_u32 m0, s62, s61
    s_lshl_b32 s61, s60, 13
    s_add_u32 s61, s61, s57
    s_and_b32 s60, s60, 3
    s_lshl_b32 s60, s60, 6
    v_xor_b32 v6, s60, v5
    buffer_load_dwordx4 v6, s[8:11], s61 offen lds
    s_add_u32 m0, m0, 8192
    s_add_u32 s61, s61, s58
    buffer_load_dwordx4 v6, s[8:11], s61 offen lds
    s_add_u32 s60, s59, 1
    s_and_b32 s60, s60, 7
    s_lshl_b32 s61, s60, 10
    s_add_u32 m0, s62, s61
    s_lshl_b32 s61, s60, 13
    s_add_u32 s61, s61, s57
    s_and_b32 s60, s60, 3
    s_lshl_b32 s60, s60, 6
    v_xor_b32 v6, s60, v5
    buffer_load_dwordx4 v6, s[8:11], s61 offen lds
    s_add_u32 m0, m0, 8192
    s_add_u32 s61, s61, s58
    buffer_load_dwordx4 v6, s[8:11], s61 offen lds
    s_add_u32 s60, s59, 2
    s_and_b32 s60, s60, 7
    s_lshl_b32 s61, s60, 10
    s_add_u32 m0, s62, s61
    s_lshl_b32 s61, s60, 13
    s_add_u32 s61, s61, s57
    s_and_b32 s60, s60, 3
    s_lshl_b32 s60, s60, 6
    v_xor_b32 v6, s60, v5
    buffer_load_dwordx4 v6, s[8:11], s61 offen lds
    s_add_u32 m0, m0, 8192
    s_add_u32 s61, s61, s58
    buffer_load_dwordx4 v6, s[8:11], s61 offen lds
    s_add_u32 s60, s59, 3
    s_and_b32 s60, s60, 7
    s_lshl_b32 s61, s60, 10
    s_add_u32 m0, s62, s61
    s_lshl_b32 s61, s60, 13
    s_add_u32 s61, s61, s57
    s_and_b32 s60, s60, 3
    s_lshl_b32 s60, s60, 6
    v_xor_b32 v6, s60, v5
    buffer_load_dwordx4 v6, s[8:11], s61 offen lds
    s_add_u32 m0, m0, 8192
    s_add_u32 s61, s61, s58
    buffer_load_dwordx4 v6, s[8:11], s61 offen lds
    s_add_u32 s60, s59, 4
    s_and_b32 s60, s60, 7
    s_lshl_b32 s61, s60, 10
    s_add_u32 m0, s62, s61
    s_lshl_b32 s61, s60, 13
    s_add_u32 s61, s61, s57
    s_and_b32 s60, s60, 3
    s_lshl_b32 s60, s60, 6
    v_xor_b32 v6, s60, v5
    buffer_load_dwordx4 v6, s[8:11], s61 offen lds
    s_add_u32 m0, m0, 8192
    s_add_u32 s61, s61, s58
    buffer_load_dwordx4 v6, s[8:11], s61 offen lds
    s_add_u32 s60, s59, 5
    s_and_b32 s60, s60, 7
    s_lshl_b32 s61, s60, 10
    s_add_u32 m0, s62, s61
    s_lshl_b32 s61, s60, 13
    s_add_u32 s61, s61, s57
    s_and_b32 s60, s60, 3
    s_lshl_b32 s60, s60, 6
    v_xor_b32 v6, s60, v5
    buffer_load_dwordx4 v6, s[8:11], s61 offen lds
    s_add_u32 m0, m0, 8192
    s_add_u32 s61, s61, s58
    buffer_load_dwordx4 v6, s[8:11], s61 offen lds
    s_add_u32 s60, s59, 6
    s_and_b32 s60, s60, 7
    s_lshl_b32 s61, s60, 10
    s_add_u32 m0, s62, s61
    s_lshl_b32 s61, s60, 13
    s_add_u32 s61, s61, s57
    s_and_b32 s60, s60, 3
    s_lshl_b32 s60, s60, 6
    v_xor_b32 v6, s60, v5
    buffer_load_dwordx4 v6, s[8:11], s61 offen lds
    s_add_u32 m0, m0, 8192
    s_add_u32 s61, s61, s58
    buffer_load_dwordx4 v6, s[8:11], s61 offen lds
    s_add_u32 s60, s59, 7
    s_and_b32 s60, s60, 7
    s_lshl_b32 s61, s60, 10
    s_add_u32 m0, s62, s61
    s_lshl_b32 s61, s60, 13
    s_add_u32 s61, s61, s57
    s_and_b32 s60, s60, 3
    s_lshl_b32 s60, s60, 6
    v_xor_b32 v6, s60, v5
    buffer_load_dwordx4 v6, s[8:11], s61 offen lds
    s_add_u32 m0, m0, 8192
    s_add_u32 s61, s61, s58
    buffer_load_dwordx4 v6, s[8:11], s61 offen lds
C_F1LD:
    v_lshrrev_b32 v3, 5, v0
    v_bfe_u32 v4, v0, 2, 2
    v_bfe_u32 v5, v0, 4, 1
    v_lshlrev_b32 v5, 5, v5
    v_and_b32 v6, 3, v0
    v_lshl_add_u32 v5, v6, 3, v5
    v_and_b32 v8, 31, v0
    v_and_b32 v9, 15, v0
    v_xor_b32 v9, v9, v3
    v_lshlrev_b32 v9, 4, v9
    v_lshl_add_u32 v6, v8, 8, v9
    v_bfe_u32 v9, v0, 1, 3
    v_xor_b32 v9, v9, v3
    v_lshlrev_b32 v9, 4, v9
    v_lshl_add_u32 v7, v8, 7, v9
    v_lshl_add_u32 v8, v3, 3, v4
    v_xor_b32 v9, s56, v4
    v_lshl_add_u32 v9, v9, 6, v5
    v_lshl_add_u32 v10, v8, 8, v9
    s_lshl_b32 s71, s4, 1
    s_add_u32 s71, s71, s6
    s_lshl_b32 s60, s71, 1
    s_add_u32 s60, s60, s7
    s_sub_u32 s60, s60, 2
    s_lshl_b32 s60, s60, 7
    s_add_u32 s63, s60, 2949120
    s_cmp_eq_u32 s75, 0
    s_cselect_b32 s63, s63, 1073741824
    s_lshl_b32 s72, s5, 1
    s_lshr_b32 s60, s56, 1
    s_add_u32 s72, s72, s60
    s_sub_u32 s72, s72, s54
    s_and_b32 s72, s72, 15
    v_add_u32 v160, s62, v6
    v_add_u32 v7, 81920, v7
    s_cmp_eq_u32 s55, s6
    s_cselect_b32 s64, 16384, 0
    s_movk_i32 s65, 128
    s_cselect_b32 s65, s65, 4096
    s_cbranch_scc1 C_P2X
    v_mov_b32 v6, v7
C_P2X:
    v_mov_b32 v1, v10
    v_mov_b32 v8, v6
    v_xor_b32 v12, s65, v6
    v_xor_b32 v9, 32, v8
    v_xor_b32 v10, 64, v8
    v_xor_b32 v11, 96, v8
    v_xor_b32 v13, 32, v12
    v_xor_b32 v14, 64, v12
    v_xor_b32 v15, 96, v12
    v_add_u32 v6, 131072, v1
    v_add_u32 v7, 65536, v1
    s_waitcnt lgkmcnt(0)
    s_mul_i32 s52, s52, 0x9e3779b1
    s_add_u32 s52, s52, 0x7f4a7c15
    s_cmp_eq_u32 s74, 1
    s_cbranch_scc1 C_F1H
    s_cmp_eq_u32 s7, 3
    s_cbranch_scc0 C_F1C
    s_barrier
    s_barrier
    s_branch C_F1A
C_F1C:
    s_cmp_eq_u32 s7, 2
    s_cbranch_scc1 C_F1RG2
    v_lshl_add_u32 v1, v3, 3, v4
    v_lshl_add_u32 v1, v1, 6, v5
    s_add_u32 s60, s62, 65536
    v_add_u32 v1, s60, v1
    s_waitcnt vmcnt(0)
    ds_read_b64_tr_b16 v[96:97], v1 offset:0
    ds_read_b64_tr_b16 v[98:99], v1 offset:256
    ds_read_b64_tr_b16 v[100:101], v1 offset:1024
    ds_read_b64_tr_b16 v[102:103], v1 offset:1280
    ds_read_b64_tr_b16 v[104:105], v1 offset:2048
    ds_read_b64_tr_b16 v[106:107], v1 offset:2304
    ds_read_b64_tr_b16 v[108:109], v1 offset:3072
    ds_read_b64_tr_b16 v[110:111], v1 offset:3328
    ds_read_b64_tr_b16 v[112:113], v1 offset:4096
    ds_read_b64_tr_b16 v[114:115], v1 offset:4352
    ds_read_b64_tr_b16 v[116:117], v1 offset:5120
    ds_read_b64_tr_b16 v[118:119], v1 offset:5376
    ds_read_b64_tr_b16 v[120:121], v1 offset:6144
    ds_read_b64_tr_b16 v[122:123], v1 offset:6400
    ds_read_b64_tr_b16 v[124:125], v1 offset:7168
    ds_read_b64_tr_b16 v[126:127], v1 offset:7424
    ds_read_b64_tr_b16 v[128:129], v1 offset:8192
    ds_read_b64_tr_b16 v[130:131], v1 offset:8448
    ds_read_b64_tr_b16 v[132:133], v1 offset:9216
    ds_read_b64_tr_b16 v[134:135], v1 offset:9472
    ds_read_b64_tr_b16 v[136:137], v1 offset:10240
    ds_read_b64_tr_b16 v[138:139], v1 offset:10496
    ds_read_b64_tr_b16 v[140:141], v1 offset:11264
    ds_read_b64_tr_b16 v[142:143], v1 offset:11520
    ds_read_b64_tr_b16 v[144:145], v1 offset:12288
    ds_read_b64_tr_b16 v[146:147], v1 offset:12544
    ds_read_b64_tr_b16 v[148:149], v1 offset:13312
    ds_read_b64_tr_b16 v[150:151], v1 offset:13568
    ds_read_b64_tr_b16 v[152:153], v1 offset:14336
    ds_read_b64_tr_b16 v[154:155], v1 offset:14592
    ds_read_b64_tr_b16 v[156:157], v1 offset:15360
    ds_read_b64_tr_b16 v[158:159], v1 offset:15616
    s_branch C_F1MM
C_F1RG2:
    v_and_b32 v1, 31, v0
    v_mov_b32 v16, 512
    v_cmp_eq_u32 vcc, 0, v1
    s_nop 1
    v_cndmask_b32 v16, v16, 0, vcc
    v_mov_b32 v17, 1024
    v_cmp_eq_u32 vcc, 1, v1
    s_nop 1
    v_cndmask_b32 v16, v16, v17, vcc
    v_lshl_add_u32 v1, v3, 4, v16
    s_add_u32 s60, s62, 65536
    v_add_u32 v1, s60, v1
    s_waitcnt vmcnt(0)
    ds_read_b128 v[96:99], v1 offset:0
    ds_read_b128 v[100:103], v1 offset:32
    ds_read_b128 v[104:107], v1 offset:64
    ds_read_b128 v[108:111], v1 offset:96
    ds_read_b128 v[112:115], v1 offset:128
    ds_read_b128 v[116:119], v1 offset:160
    ds_read_b128 v[120:123], v1 offset:192
    ds_read_b128 v[124:127], v1 offset:224
    ds_read_b128 v[128:131], v1 offset:256
    ds_read_b128 v[132:135], v1 offset:288
    ds_read_b128 v[136:139], v1 offset:320
    ds_read_b128 v[140:143], v1 offset:352
    ds_read_b128 v[144:147], v1 offset:384
    ds_read_b128 v[148:151], v1 offset:416
    ds_read_b128 v[152:155], v1 offset:448
    ds_read_b128 v[156:159], v1 offset:480
C_F1MM:
    s_cmp_lg_u32 s7, 1
    s_cbranch_scc1 C_F1NP
    v_and_b32 v16, 19, v0
    v_and_b32 v17, 4, v0
    v_lshl_or_b32 v16, v17, 1, v16
    v_bfe_u32 v17, v0, 3, 1
    v_lshl_or_b32 v16, v17, 2, v16
    v_and_b32 v17, 15, v16
    v_xor_b32 v17, v17, v3
    v_lshlrev_b32 v17, 4, v17
    v_lshl_add_u32 v16, v16, 8, v17
    v_add_u32 v160, s62, v16
C_F1NP:
    v_xor_b32 v161, 32, v160
    v_xor_b32 v162, 64, v160
    v_xor_b32 v163, 96, v160
    v_xor_b32 v164, 128, v160
    v_xor_b32 v165, 160, v160
    v_xor_b32 v166, 192, v160
    v_xor_b32 v167, 224, v160
    s_lshl_b32 s60, s75, 12
    s_add_u32 s60, s60, 114688
    v_add_u32 v1, s60, v2
    s_waitcnt lgkmcnt(0)
    s_barrier
    s_barrier
    ds_read_b128 v[32:35], v160 offset:0
    ds_read_b128 v[36:39], v161 offset:0
    ds_read_b128 v[40:43], v162 offset:0
    ds_read_b128 v[44:47], v163 offset:0
    ds_read_b128 v[48:51], v164 offset:0
    ds_read_b128 v[52:55], v165 offset:0
    ds_read_b128 v[56:59], v166 offset:0
    ds_read_b128 v[60:63], v167 offset:0
    ds_read_b128 v[64:67], v160 offset:8192
    ds_read_b128 v[68:71], v161 offset:8192
    ds_read_b128 v[72:75], v162 offset:8192
    ds_read_b128 v[76:79], v163 offset:8192
    ds_read_b128 v[80:83], v164 offset:8192
    ds_read_b128 v[84:87], v165 offset:8192
    ds_read_b128 v[88:91], v166 offset:8192
    ds_read_b128 v[92:95], v167 offset:8192
    s_cmp_eq_u32 s7, 1
    s_cbranch_scc1 C_F1V
    s_waitcnt lgkmcnt(15)
    v_mfma_f32_32x32x16_bf16 v[16:31], v[96:99], v[32:35], 0
    s_waitcnt lgkmcnt(14)
    v_mfma_f32_32x32x16_bf16 v[16:31], v[100:103], v[36:39], v[16:31]
    s_waitcnt lgkmcnt(13)
    v_mfma_f32_32x32x16_bf16 v[16:31], v[104:107], v[40:43], v[16:31]
    s_waitcnt lgkmcnt(12)
    v_mfma_f32_32x32x16_bf16 v[16:31], v[108:111], v[44:47], v[16:31]
    s_waitcnt lgkmcnt(11)
    v_mfma_f32_32x32x16_bf16 v[16:31], v[112:115], v[48:51], v[16:31]
    s_waitcnt lgkmcnt(10)
    v_mfma_f32_32x32x16_bf16 v[16:31], v[116:119], v[52:55], v[16:31]
    s_waitcnt lgkmcnt(9)
    v_mfma_f32_32x32x16_bf16 v[16:31], v[120:123], v[56:59], v[16:31]
    s_waitcnt lgkmcnt(8)
    v_mfma_f32_32x32x16_bf16 v[16:31], v[124:127], v[60:63], v[16:31]
    s_waitcnt lgkmcnt(7)
    v_mfma_f32_32x32x16_bf16 v[16:31], v[128:131], v[64:67], v[16:31]
    s_waitcnt lgkmcnt(6)
    v_mfma_f32_32x32x16_bf16 v[16:31], v[132:135], v[68:71], v[16:31]
    s_waitcnt lgkmcnt(5)
    v_mfma_f32_32x32x16_bf16 v[16:31], v[136:139], v[72:75], v[16:31]
    s_waitcnt lgkmcnt(4)
    v_mfma_f32_32x32x16_bf16 v[16:31], v[140:143], v[76:79], v[16:31]
    s_waitcnt lgkmcnt(3)
    v_mfma_f32_32x32x16_bf16 v[16:31], v[144:147], v[80:83], v[16:31]
    s_waitcnt lgkmcnt(2)
    v_mfma_f32_32x32x16_bf16 v[16:31], v[148:151], v[84:87], v[16:31]
    s_waitcnt lgkmcnt(1)
    v_mfma_f32_32x32x16_bf16 v[16:31], v[152:155], v[88:91], v[16:31]
    s_waitcnt lgkmcnt(0)
    v_mfma_f32_32x32x16_bf16 v[16:31], v[156:159], v[92:95], v[16:31]
    s_branch C_F1W
C_F1V:
    s_waitcnt lgkmcnt(15)
    v_mfma_f32_32x32x16_bf16 v[16:31], v[32:35], v[96:99], 0
    s_waitcnt lgkmcnt(14)
    v_mfma_f32_32x32x16_bf16 v[16:31], v[36:39], v[100:103], v[16:31]
    s_waitcnt lgkmcnt(13)
    v_mfma_f32_32x32x16_bf16 v[16:31], v[40:43], v[104:107], v[16:31]
    s_waitcnt lgkmcnt(12)
    v_mfma_f32_32x32x16_bf16 v[16:31], v[44:47], v[108:111], v[16:31]
    s_waitcnt lgkmcnt(11)
    v_mfma_f32_32x32x16_bf16 v[16:31], v[48:51], v[112:115], v[16:31]
    s_waitcnt lgkmcnt(10)
    v_mfma_f32_32x32x16_bf16 v[16:31], v[52:55], v[116:119], v[16:31]
    s_waitcnt lgkmcnt(9)
    v_mfma_f32_32x32x16_bf16 v[16:31], v[56:59], v[120:123], v[16:31]
    s_waitcnt lgkmcnt(8)
    v_mfma_f32_32x32x16_bf16 v[16:31], v[60:63], v[124:127], v[16:31]
    s_waitcnt lgkmcnt(7)
    v_mfma_f32_32x32x16_bf16 v[16:31], v[64:67], v[128:131], v[16:31]
    s_waitcnt lgkmcnt(6)
    v_mfma_f32_32x32x16_bf16 v[16:31], v[68:71], v[132:135], v[16:31]
    s_waitcnt lgkmcnt(5)
    v_mfma_f32_32x32x16_bf16 v[16:31], v[72:75], v[136:139], v[16:31]
    s_waitcnt lgkmcnt(4)
    v_mfma_f32_32x32x16_bf16 v[16:31], v[76:79], v[140:143], v[16:31]
    s_waitcnt lgkmcnt(3)
    v_mfma_f32_32x32x16_bf16 v[16:31], v[80:83], v[144:147], v[16:31]
    s_waitcnt lgkmcnt(2)
    v_mfma_f32_32x32x16_bf16 v[16:31], v[84:87], v[148:151], v[16:31]
    s_waitcnt lgkmcnt(1)
    v_mfma_f32_32x32x16_bf16 v[16:31], v[88:91], v[152:155], v[16:31]
    s_waitcnt lgkmcnt(0)
    v_mfma_f32_32x32x16_bf16 v[16:31], v[92:95], v[156:159], v[16:31]
C_F1W:
    s_nop 11
    ds_write_b128 v1, v[16:19] offset:0
    ds_write_b128 v1, v[20:23] offset:1024
    ds_write_b128 v1, v[24:27] offset:2048
    ds_write_b128 v1, v[28:31] offset:3072
C_F1A:
    s_waitcnt vmcnt(0) lgkmcnt(0)
    s_barrier
    s_branch C_F1B
C_F1H:
    s_barrier
    s_waitcnt vmcnt(0)
    s_barrier
    s_lshl_b32 s60, s75, 11
    s_add_u32 s60, s60, 114688
    v_add_u32 v1, s60, v2
    s_waitcnt lgkmcnt(0)
    s_barrier
    s_cmp_ge_u32 s75, 2
    s_cbranch_scc1 C_F1B
    s_cmp_eq_u32 s7, 3
    s_cbranch_scc1 C_F1B
    ds_read_b128 v[96:99], v1 offset:0
    ds_read_b128 v[100:103], v1 offset:1024
    ds_read_b128 v[104:107], v1 offset:4096
    ds_read_b128 v[108:111], v1 offset:5120
    ds_read_b128 v[112:115], v1 offset:8192
    ds_read_b128 v[116:119], v1 offset:9216
    ds_read_b128 v[120:123], v1 offset:12288
    ds_read_b128 v[124:127], v1 offset:13312
    s_waitcnt lgkmcnt(4)
    v_add_f32 v96, v96, v104
    v_add_f32 v97, v97, v105
    v_add_f32 v98, v98, v106
    v_add_f32 v99, v99, v107
    v_add_f32 v100, v100, v108
    v_add_f32 v101, v101, v109
    v_add_f32 v102, v102, v110
    v_add_f32 v103, v103, v111
    s_waitcnt lgkmcnt(2)
    v_add_f32 v96, v96, v112
    v_add_f32 v97, v97, v113
    v_add_f32 v98, v98, v114
    v_add_f32 v99, v99, v115
    v_add_f32 v100, v100, v116
    v_add_f32 v101, v101, v117
    v_add_f32 v102, v102, v118
    v_add_f32 v103, v103, v119
    s_waitcnt lgkmcnt(0)
    v_add_f32 v96, v96, v120
    v_add_f32 v97, v97, v121
    v_add_f32 v98, v98, v122
    v_add_f32 v99, v99, v123
    v_add_f32 v100, v100, v124
    v_add_f32 v101, v101, v125
    v_add_f32 v102, v102, v126
    v_add_f32 v103, v103, v127
    s_cmp_eq_u32 s7, 2
    s_cbranch_scc1 C_PUBR
    v_cvt_pk_bf16_f32 v104, v96, v97
    v_cvt_pk_bf16_f32 v105, v98, v99
    v_cvt_pk_bf16_f32 v106, v100, v101
    v_cvt_pk_bf16_f32 v107, v102, v103
    s_add_u32 s61, s71, 1
    s_add_u32 s61, s61, s75
    s_and_b32 s61, s61, 63
    s_lshl_b32 s61, s61, 12
    s_add_u32 s61, s61, 2048
    s_lshl_b32 s60, s71, 12
    s_cmp_eq_u32 s7, 0
    s_cselect_b32 s60, s60, s61
    s_lshl_b32 s61, s75, 10
    s_add_u32 s60, s60, s61
    s_lshr_b32 s63, s60, 3
    s_add_u32 s63, s63, 2883584
    s_add_u32 s60, s60, 8388608
    buffer_store_dwordx4 v[104:107], v2, s[20:23], s60 offen sc1
    s_branch C_F1B
C_PUBR:
    s_cmp_eq_u32 s75, 1
    s_cbranch_scc1 C_F1B
    s_lshl_b32 s61, s71, 5
    v_add_u32 v104, s61, v0
    v_cvt_pk_bf16_f32 v105, v96, v96
    v_and_b32 v105, 0xffff, v105
    v_xor_b32 v106, 0xffff, v105
    v_or_b32 v107, 0x8000, v105
    v_cmp_lt_u32 vcc, 0x7fff, v105
    s_nop 1
    v_cndmask_b32 v105, v107, v106, vcc
    v_sub_u32 v106, 0xffff, v104
    v_lshl_or_b32 v105, v105, 16, v106
    v_mul_f32 v108, 0xbfb8aa3b, v97
    v_exp_f32 v108, v108
    s_nop 0
    v_add_f32 v108, 1.0, v108
    v_rcp_f32 v108, v108
    v_lshlrev_b32 v104, 2, v104
    v_mov_b32 v109, 0x40000000
    v_cmp_gt_u32 vcc, 32, v0
    s_nop 1
    v_cndmask_b32 v104, v109, v104, vcc
    s_mov_b32 s61, 8658944
    buffer_store_dword v105, v104, s[20:23], s61 offen sc1
    s_mov_b32 s61, 8650752
    buffer_store_dword v108, v104, s[20:23], s61 offen sc1
    v_mov_b32 v110, v105
    s_nop 1
    v_max_u32_dpp v110, v110, v110 row_shr:1 row_mask:0xf bank_mask:0xf
    s_nop 1
    v_max_u32_dpp v110, v110, v110 row_shr:2 row_mask:0xf bank_mask:0xf
    s_nop 1
    v_max_u32_dpp v110, v110, v110 row_shr:4 row_mask:0xf bank_mask:0xf
    s_nop 1
    v_max_u32_dpp v110, v110, v110 row_shr:8 row_mask:0xf bank_mask:0xf
    s_nop 1
    v_max_u32_dpp v110, v110, v110 row_bcast:15 row_mask:0xa bank_mask:0xf
    v_cmp_eq_u32 vcc, 31, v0
    s_nop 1
    v_cndmask_b32 v111, v109, 0, vcc
    s_lshl_b32 s60, s71, 2
    s_add_u32 s60, s60, 8667136
    buffer_store_dword v110, v111, s[20:23], s60 offen sc1
C_F1B:
    ds_read_b128 v[32:35], v8 offset:0
    ds_read_b64_tr_b16 v[48:49], v6 offset:0
    ds_read_b64_tr_b16 v[50:51], v6 offset:1024
    ds_read_b128 v[36:39], v9 offset:0
    ds_read_b64_tr_b16 v[52:53], v6 offset:4096
    ds_read_b64_tr_b16 v[54:55], v6 offset:5120
    ds_read_b128 v[40:43], v10 offset:0
    ds_read_b64_tr_b16 v[56:57], v6 offset:8192
    ds_read_b64_tr_b16 v[58:59], v6 offset:9216
    ds_read_b128 v[44:47], v11 offset:0
    ds_read_b64_tr_b16 v[60:61], v6 offset:12288
    ds_read_b64_tr_b16 v[62:63], v6 offset:13312
    v_lshrrev_b32 v1, 4, v0
    v_lshlrev_b32 v5, 2, v1
    v_and_b32 v16, 15, v0
    v_xor_b32 v16, v16, v5
    v_lshlrev_b32 v16, 4, v16
    v_lshl_add_u32 v5, v1, 11, v16
    s_lshl_b32 s60, s75, 15
    s_lshl_b32 s61, s5, 8
    s_add_u32 s60, s60, s61
    s_add_u32 s60, s60, 16384
    v_add_u32 v5, s60, v5
    s_lshl_b32 s66, s75, 12
    s_add_u32 s66, s66, 2048
    s_cmp_eq_u32 s74, 0
    s_cselect_b64 vcc, -1, 0
    v_mov_b32 v16, 0
    v_mov_b32 v17, 0
    v_mov_b32 v18, 0
    v_mov_b32 v19, 0
    v_mov_b32 v20, 0
    v_mov_b32 v21, 0
    v_mov_b32 v22, 0
    v_mov_b32 v23, 0
    v_mov_b32 v24, 0
    v_mov_b32 v25, 0
    v_mov_b32 v26, 0
    v_mov_b32 v27, 0
    v_mov_b32 v28, 0
    v_mov_b32 v29, 0
    v_mov_b32 v30, 0
    v_mov_b32 v31, 0
    s_barrier
    ds_read_b128 v[64:67], v12 offset:0
    ds_read_b64_tr_b16 v[80:81], v6 offset:16384
    ds_read_b64_tr_b16 v[82:83], v6 offset:17408
    ds_read_b128 v[68:71], v13 offset:0
    ds_read_b64_tr_b16 v[84:85], v6 offset:20480
    ds_read_b64_tr_b16 v[86:87], v6 offset:21504
    ds_read_b128 v[72:75], v14 offset:0
    ds_read_b64_tr_b16 v[88:89], v6 offset:24576
    ds_read_b64_tr_b16 v[90:91], v6 offset:25600
    ds_read_b128 v[76:79], v15 offset:0
    ds_read_b64_tr_b16 v[92:93], v6 offset:28672
    ds_read_b64_tr_b16 v[94:95], v6 offset:29696
    s_mov_b32 s67, 0
    s_mov_b32 s68, 3
C_P2L:
    s_waitcnt lgkmcnt(12)
    s_barrier
    v_mfma_f32_32x32x16_bf16 v[16:31], v[48:51], v[32:35], v[16:31]
    ds_read_b128 v[96:99], v8 offset:8192
    ds_read_b64_tr_b16 v[112:113], v7 offset:0
    ds_read_b64_tr_b16 v[114:115], v7 offset:1024
    s_sub_u32 s72, s72, 1
    s_cbranch_scc1 C_XO1
C_XC1:
    v_mfma_f32_32x32x16_bf16 v[16:31], v[52:55], v[36:39], v[16:31]
    ds_read_b128 v[100:103], v9 offset:8192
    ds_read_b64_tr_b16 v[116:117], v7 offset:4096
    ds_read_b64_tr_b16 v[118:119], v7 offset:5120
    v_mfma_f32_32x32x16_bf16 v[16:31], v[56:59], v[40:43], v[16:31]
    ds_read_b128 v[104:107], v10 offset:8192
    ds_read_b64_tr_b16 v[120:121], v7 offset:8192
    ds_read_b64_tr_b16 v[122:123], v7 offset:9216
    v_mfma_f32_32x32x16_bf16 v[16:31], v[60:63], v[44:47], v[16:31]
    ds_read_b128 v[108:111], v11 offset:8192
    ds_read_b64_tr_b16 v[124:125], v7 offset:12288
    ds_read_b64_tr_b16 v[126:127], v7 offset:13312
    s_add_u32 s68, s68, 1
    s_waitcnt lgkmcnt(12)
    s_barrier
    v_mfma_f32_32x32x16_bf16 v[16:31], v[80:83], v[64:67], v[16:31]
    ds_read_b128 v[128:131], v12 offset:8192
    ds_read_b64_tr_b16 v[144:145], v7 offset:32768
    ds_read_b64_tr_b16 v[146:147], v7 offset:33792
    v_add_u32 v8, s64, v8
    s_sub_u32 s72, s72, 1
    s_cbranch_scc1 C_XO2
C_XC2:
    v_mfma_f32_32x32x16_bf16 v[16:31], v[84:87], v[68:71], v[16:31]
    ds_read_b128 v[132:135], v13 offset:8192
    ds_read_b64_tr_b16 v[148:149], v7 offset:36864
    ds_read_b64_tr_b16 v[150:151], v7 offset:37888
    v_add_u32 v9, s64, v9
    s_cmp_eq_u32 s67, 0
    s_cbranch_scc1 C_PUBF
C_PUBJ:
    v_mfma_f32_32x32x16_bf16 v[16:31], v[88:91], v[72:75], v[16:31]
    ds_read_b128 v[136:139], v14 offset:8192
    ds_read_b64_tr_b16 v[152:153], v7 offset:40960
    ds_read_b64_tr_b16 v[154:155], v7 offset:41984
    v_add_u32 v10, s64, v10
    v_mfma_f32_32x32x16_bf16 v[16:31], v[92:95], v[76:79], v[16:31]
    ds_read_b128 v[140:143], v15 offset:8192
    ds_read_b64_tr_b16 v[156:157], v7 offset:45056
    ds_read_b64_tr_b16 v[158:159], v7 offset:46080
    v_add_u32 v11, s64, v11
    s_add_u32 s68, s68, 1
    s_waitcnt lgkmcnt(12)
    s_barrier
    v_mfma_f32_32x32x16_bf16 v[16:31], v[112:115], v[96:99], v[16:31]
    ds_read_b128 v[32:35], v8 offset:0
    ds_read_b64_tr_b16 v[48:49], v6 offset:0
    ds_read_b64_tr_b16 v[50:51], v6 offset:1024
    v_add_u32 v12, s64, v12
    s_sub_u32 s72, s72, 1
    s_cbranch_scc1 C_XO3
C_XC3:
    v_mfma_f32_32x32x16_bf16 v[16:31], v[116:119], v[100:103], v[16:31]
    ds_read_b128 v[36:39], v9 offset:0
    ds_read_b64_tr_b16 v[52:53], v6 offset:4096
    ds_read_b64_tr_b16 v[54:55], v6 offset:5120
    v_add_u32 v13, s64, v13
    v_mfma_f32_32x32x16_bf16 v[16:31], v[120:123], v[104:107], v[16:31]
    ds_read_b128 v[40:43], v10 offset:0
    ds_read_b64_tr_b16 v[56:57], v6 offset:8192
    ds_read_b64_tr_b16 v[58:59], v6 offset:9216
    v_add_u32 v14, s64, v14
    v_mfma_f32_32x32x16_bf16 v[16:31], v[124:127], v[108:111], v[16:31]
    ds_read_b128 v[44:47], v11 offset:0
    ds_read_b64_tr_b16 v[60:61], v6 offset:12288
    ds_read_b64_tr_b16 v[62:63], v6 offset:13312
    v_add_u32 v15, s64, v15
    s_add_u32 s68, s68, 1
    s_waitcnt lgkmcnt(12)
    s_barrier
    v_mfma_f32_32x32x16_bf16 v[16:31], v[144:147], v[128:131], v[16:31]
    ds_read_b128 v[64:67], v12 offset:0
    ds_read_b64_tr_b16 v[80:81], v6 offset:16384
    ds_read_b64_tr_b16 v[82:83], v6 offset:17408
    s_sub_u32 s72, s72, 1
    s_cbranch_scc1 C_XO4
C_XC4:
    v_mfma_f32_32x32x16_bf16 v[16:31], v[148:151], v[132:135], v[16:31]
    ds_read_b128 v[68:71], v13 offset:0
    ds_read_b64_tr_b16 v[84:85], v6 offset:20480
    ds_read_b64_tr_b16 v[86:87], v6 offset:21504
    s_add_u32 s68, s68, 1
    v_mfma_f32_32x32x16_bf16 v[16:31], v[152:155], v[136:139], v[16:31]
    ds_read_b128 v[72:75], v14 offset:0
    ds_read_b64_tr_b16 v[88:89], v6 offset:24576
    ds_read_b64_tr_b16 v[90:91], v6 offset:25600
    s_add_u32 s67, s67, 4
    s_cmp_lt_u32 s67, 12
    v_mfma_f32_32x32x16_bf16 v[16:31], v[156:159], v[140:143], v[16:31]
    ds_read_b128 v[76:79], v15 offset:0
    ds_read_b64_tr_b16 v[92:93], v6 offset:28672
    ds_read_b64_tr_b16 v[94:95], v6 offset:29696
    s_cbranch_scc1 C_P2L
    s_waitcnt lgkmcnt(12)
    s_barrier
    v_mfma_f32_32x32x16_bf16 v[16:31], v[48:51], v[32:35], v[16:31]
    ds_read_b128 v[96:99], v8 offset:8192
    ds_read_b64_tr_b16 v[112:113], v7 offset:0
    ds_read_b64_tr_b16 v[114:115], v7 offset:1024
    s_sub_u32 s72, s72, 1
    s_cbranch_scc1 C_XO5
C_XC5:
    v_mfma_f32_32x32x16_bf16 v[16:31], v[52:55], v[36:39], v[16:31]
    ds_read_b128 v[100:103], v9 offset:8192
    ds_read_b64_tr_b16 v[116:117], v7 offset:4096
    ds_read_b64_tr_b16 v[118:119], v7 offset:5120
    v_mfma_f32_32x32x16_bf16 v[16:31], v[56:59], v[40:43], v[16:31]
    ds_read_b128 v[104:107], v10 offset:8192
    ds_read_b64_tr_b16 v[120:121], v7 offset:8192
    ds_read_b64_tr_b16 v[122:123], v7 offset:9216
    v_mfma_f32_32x32x16_bf16 v[16:31], v[60:63], v[44:47], v[16:31]
    ds_read_b128 v[108:111], v11 offset:8192
    ds_read_b64_tr_b16 v[124:125], v7 offset:12288
    ds_read_b64_tr_b16 v[126:127], v7 offset:13312
    s_waitcnt vmcnt(0) lgkmcnt(12)
    s_barrier
    v_mfma_f32_32x32x16_bf16 v[16:31], v[80:83], v[64:67], v[16:31]
    ds_read_b128 v[128:131], v12 offset:8192
    ds_read_b64_tr_b16 v[144:145], v7 offset:32768
    ds_read_b64_tr_b16 v[146:147], v7 offset:33792
    s_sub_u32 s72, s72, 1
    s_cbranch_scc1 C_XO6
C_XC6:
    v_mfma_f32_32x32x16_bf16 v[16:31], v[84:87], v[68:71], v[16:31]
    ds_read_b128 v[132:135], v13 offset:8192
    ds_read_b64_tr_b16 v[148:149], v7 offset:36864
    ds_read_b64_tr_b16 v[150:151], v7 offset:37888
    v_mfma_f32_32x32x16_bf16 v[16:31], v[88:91], v[72:75], v[16:31]
    ds_read_b128 v[136:139], v14 offset:8192
    ds_read_b64_tr_b16 v[152:153], v7 offset:40960
    ds_read_b64_tr_b16 v[154:155], v7 offset:41984
    v_mfma_f32_32x32x16_bf16 v[16:31], v[92:95], v[76:79], v[16:31]
    ds_read_b128 v[140:143], v15 offset:8192
    ds_read_b64_tr_b16 v[156:157], v7 offset:45056
    ds_read_b64_tr_b16 v[158:159], v7 offset:46080
    s_lshl_b32 s69, s4, 1
    s_add_u32 s69, s69, s55
    s_lshl_b32 s69, s69, 5
    v_and_b32 v7, 31, v0
    v_add_u32 v7, s69, v7
    v_lshlrev_b32 v7, 11, v7
    v_lshl_add_u32 v7, v3, 4, v7
    s_lshl_b32 s60, s5, 8
    s_lshl_b32 s61, s56, 6
    s_add_u32 s70, s60, s61
    v_lshl_add_u32 v1, v3, 2, v4
    v_xor_b32 v4, s56, v4
    v_lshlrev_b32 v4, 6, v4
    v_lshl_add_u32 v4, v1, 8, v4
    v_and_b32 v1, 1, v0
    v_lshl_add_u32 v4, v1, 4, v4
    v_and_b32 v1, 16, v0
    v_lshl_add_u32 v4, v1, 1, v4
    v_and_b32 v1, 2, v0
    v_lshl_add_u32 v4, v1, 2, v4
    s_lshl_b32 s60, s55, 12
    s_add_u32 s60, s60, 81920
    v_add_u32 v5, s60, v2
    s_lshl_b32 s60, s4, 3
    s_add_u32 s60, s60, s5
    s_lshl_b32 s60, s60, 3
    s_add_u32 s60, s60, s3
    s_lshl_b32 s60, s60, 7
    s_add_u32 s73, s60, 2359296
    s_waitcnt lgkmcnt(12)
    v_mfma_f32_32x32x16_bf16 v[16:31], v[112:115], v[96:99], v[16:31]
    s_sub_u32 s72, s72, 1
    s_cbranch_scc1 C_XO7
C_XC7:
    v_mfma_f32_32x32x16_bf16 v[16:31], v[116:119], v[100:103], v[16:31]
    v_mfma_f32_32x32x16_bf16 v[16:31], v[120:123], v[104:107], v[16:31]
    v_mfma_f32_32x32x16_bf16 v[16:31], v[124:127], v[108:111], v[16:31]
    v_mov_b32 v72, 0
    v_mov_b32 v73, 0
    v_mov_b32 v74, 0
    v_mov_b32 v75, 0
    v_mov_b32 v76, 0
    v_mov_b32 v77, 0
    v_mov_b32 v78, 0
    v_mov_b32 v79, 0
    v_mov_b32 v80, 0
    v_mov_b32 v81, 0
    v_mov_b32 v82, 0
    v_mov_b32 v83, 0
    v_mov_b32 v84, 0
    v_mov_b32 v85, 0
    v_mov_b32 v86, 0
    v_mov_b32 v87, 0
    v_mov_b32 v88, 0
    v_mov_b32 v89, 0
    v_mov_b32 v90, 0
    v_mov_b32 v91, 0
    v_mov_b32 v56, 0
    v_mov_b32 v57, 0
    v_mov_b32 v58, 0
    v_mov_b32 v59, 0
    v_mov_b32 v60, 0
    v_mov_b32 v61, 0
    v_mov_b32 v62, 0
    v_mov_b32 v63, 0
    s_waitcnt lgkmcnt(0)
    v_mfma_f32_32x32x16_bf16 v[16:31], v[144:147], v[128:131], v[16:31]
    s_sub_u32 s72, s72, 1
    s_cbranch_scc1 C_XO8
C_XC8:
    v_mfma_f32_32x32x16_bf16 v[16:31], v[148:151], v[132:135], v[16:31]
    v_mfma_f32_32x32x16_bf16 v[16:31], v[152:155], v[136:139], v[16:31]
    v_mfma_f32_32x32x16_bf16 v[16:31], v[156:159], v[140:143], v[16:31]
    v_and_b32 v6, 15, v0
    v_cmp_eq_u32 vcc, 0, v6
    v_mov_b32 v8, 0x3f803f80
    s_nop 0
    v_cndmask_b32 v92, 0, v8, vcc
    v_cmp_eq_u32 vcc, 4, v6
    s_nop 1
    v_cndmask_b32 v94, 0, v8, vcc
    v_mov_b32 v93, v92
    v_mov_b32 v95, v94
    v_mov_b32 v113, 0xdddddddd
    v_add_u32 v1, 131072, v2
    s_lshl_b32 s61, s5, 2
    s_add_u32 s60, s69, s61
    s_add_u32 s60, s60, s56
    s_lshl_b32 s60, s60, 11
    s_add_u32 s72, s60, 4194304
    s_mov_b32 s60, 0x3e8293ee
    v_mul_f32 v16, s60, v16
    v_mul_f32 v17, s60, v17
    v_mul_f32 v18, s60, v18
    v_mul_f32 v19, s60, v19
    v_mul_f32 v20, s60, v20
    v_mul_f32 v21, s60, v21
    v_mul_f32 v22, s60, v22
    v_mul_f32 v23, s60, v23
    v_mul_f32 v24, s60, v24
    v_mul_f32 v25, s60, v25
    v_mul_f32 v26, s60, v26
    v_mul_f32 v27, s60, v27
    v_mul_f32 v28, s60, v28
    v_mul_f32 v29, s60, v29
    v_mul_f32 v30, s60, v30
    v_mul_f32 v31, s60, v31
    v_cvt_pk_bf16_f32 v8, v16, v17
    v_cvt_pk_bf16_f32 v9, v18, v19
    v_cvt_pk_bf16_f32 v10, v20, v21
    v_cvt_pk_bf16_f32 v11, v22, v23
    v_cvt_pk_bf16_f32 v12, v24, v25
    v_cvt_pk_bf16_f32 v13, v26, v27
    v_cvt_pk_bf16_f32 v14, v28, v29
    v_cvt_pk_bf16_f32 v15, v30, v31
    s_barrier
    s_cmp_eq_u32 s74, 0
    s_cbranch_scc1 C_AST
    s_barrier
    s_barrier
C_AST:
    ds_read_b128 v[104:107], v1
    ds_read_b128 v[108:111], v1 offset:1024
    ds_read_b128 v[96:99], v1 offset:4096
    s_waitcnt lgkmcnt(1)
    v_mfma_f32_32x32x16_bf16 v[32:47], v[104:107], v[8:11], 0
    v_mfma_f32_32x32x16_bf16 v[32:47], v[108:111], v[12:15], v[32:47]
    ds_read_b128 v[108:111], v1 offset:7168
    ds_read_b128 v[100:103], v1 offset:5120
    ds_read_b128 v[104:107], v1 offset:6144
    s_nop 8
    v_max3_f32 v6, v32, v33, v34
    v_max3_f32 v6, v6, v35, v36
    v_max3_f32 v6, v6, v37, v38
    v_max3_f32 v6, v6, v39, v40
    v_max3_f32 v6, v6, v41, v42
    v_max3_f32 v6, v6, v43, v44
    v_max3_f32 v6, v6, v45, v46
    v_max_f32 v6, v6, v47
    v_mov_b32 v16, v6
    s_nop 1
    v_permlane32_swap_b32 v6, v16
    v_max_f32 v6, v6, v16
    v_sub_f32 v16, 0, v6
    v_mov_b32 v17, v16
    v_mov_b32 v18, v16
    v_mov_b32 v19, v16
    v_mov_b32 v20, v16
    v_mov_b32 v21, v16
    v_mov_b32 v22, v16
    v_mov_b32 v23, v16
    v_mov_b32 v24, v16
    v_mov_b32 v25, v16
    v_mov_b32 v26, v16
    v_mov_b32 v27, v16
    v_mov_b32 v28, v16
    v_mov_b32 v29, v16
    v_mov_b32 v30, v16
    v_mov_b32 v31, v16
    v_sub_f32 v32, v32, v6
    v_sub_f32 v33, v33, v6
    v_sub_f32 v34, v34, v6
    v_sub_f32 v35, v35, v6
    v_sub_f32 v36, v36, v6
    v_sub_f32 v37, v37, v6
    v_sub_f32 v38, v38, v6
    v_sub_f32 v39, v39, v6
    v_sub_f32 v40, v40, v6
    v_sub_f32 v41, v41, v6
    v_sub_f32 v42, v42, v6
    v_sub_f32 v43, v43, v6
    v_sub_f32 v44, v44, v6
    v_sub_f32 v45, v45, v6
    v_sub_f32 v46, v46, v6
    v_sub_f32 v47, v47, v6
    s_mov_b32 s67, 0
    s_setprio 2
.p2align 6
C_AL:
    v_exp_f32 v32, v32
    s_waitcnt lgkmcnt(1)
    v_smfmac_f32_32x32x32_bf16 v[72:87], v[108:111], v[56:63], v113
    ds_read_b128 v[108:111], v1 offset:11264
    v_exp_f32 v33, v33
    v_exp_f32 v34, v34
    v_exp_f32 v35, v35
    v_smfmac_f32_16x16x64_bf16 v[88:91], v[92:95], v[56:63], v113
    v_exp_f32 v36, v36
    v_mfma_f32_32x32x16_bf16 v[48:63], v[96:99], v[8:11], v[16:31]
    ds_read_b128 v[96:99], v1 offset:8192
    v_exp_f32 v37, v37
    v_exp_f32 v38, v38
    v_exp_f32 v39, v39
    v_mfma_f32_32x32x16_bf16 v[48:63], v[100:103], v[12:15], v[48:63]
    ds_read_b128 v[100:103], v1 offset:9216
    v_exp_f32 v40, v40
    v_exp_f32 v41, v41
    v_exp_f32 v42, v42
    s_waitcnt lgkmcnt(3)
    v_smfmac_f32_32x32x32_bf16 v[72:87], v[104:107], v[32:39], v113
    ds_read_b128 v[104:107], v1 offset:10240
    v_exp_f32 v43, v43
    v_exp_f32 v44, v44
    v_exp_f32 v45, v45
    v_smfmac_f32_16x16x64_bf16 v[88:91], v[92:95], v[32:39], v113
    v_exp_f32 v46, v46
    v_exp_f32 v47, v47
    v_exp_f32 v48, v48
    s_waitcnt lgkmcnt(1)
    v_smfmac_f32_32x32x32_bf16 v[72:87], v[108:111], v[40:47], v113
    ds_read_b128 v[108:111], v1 offset:15360
    v_exp_f32 v49, v49
    v_exp_f32 v50, v50
    v_exp_f32 v51, v51
    v_smfmac_f32_16x16x64_bf16 v[88:91], v[92:95], v[40:47], v113
    v_exp_f32 v52, v52
    v_mfma_f32_32x32x16_bf16 v[32:47], v[96:99], v[8:11], v[16:31]
    ds_read_b128 v[96:99], v1 offset:12288
    v_exp_f32 v53, v53
    v_exp_f32 v54, v54
    v_exp_f32 v55, v55
    v_mfma_f32_32x32x16_bf16 v[32:47], v[100:103], v[12:15], v[32:47]
    ds_read_b128 v[100:103], v1 offset:13312
    v_exp_f32 v56, v56
    v_exp_f32 v57, v57
    v_exp_f32 v58, v58
    s_waitcnt lgkmcnt(3)
    v_smfmac_f32_32x32x32_bf16 v[72:87], v[104:107], v[48:55], v113
    ds_read_b128 v[104:107], v1 offset:14336
    v_exp_f32 v59, v59
    v_exp_f32 v60, v60
    v_exp_f32 v61, v61
    v_smfmac_f32_16x16x64_bf16 v[88:91], v[92:95], v[48:55], v113
    v_exp_f32 v62, v62
    v_exp_f32 v63, v63
    v_exp_f32 v32, v32
    s_waitcnt lgkmcnt(1)
    v_smfmac_f32_32x32x32_bf16 v[72:87], v[108:111], v[56:63], v113
    ds_read_b128 v[108:111], v1 offset:19456
    v_exp_f32 v33, v33
    v_exp_f32 v34, v34
    v_exp_f32 v35, v35
    v_smfmac_f32_16x16x64_bf16 v[88:91], v[92:95], v[56:63], v113
    v_exp_f32 v36, v36
    v_mfma_f32_32x32x16_bf16 v[48:63], v[96:99], v[8:11], v[16:31]
    ds_read_b128 v[96:99], v1 offset:16384
    v_exp_f32 v37, v37
    v_exp_f32 v38, v38
    v_exp_f32 v39, v39
    v_mfma_f32_32x32x16_bf16 v[48:63], v[100:103], v[12:15], v[48:63]
    ds_read_b128 v[100:103], v1 offset:17408
    v_exp_f32 v40, v40
    v_exp_f32 v41, v41
    v_exp_f32 v42, v42
    s_waitcnt lgkmcnt(3)
    v_smfmac_f32_32x32x32_bf16 v[72:87], v[104:107], v[32:39], v113
    ds_read_b128 v[104:107], v1 offset:18432
    v_exp_f32 v43, v43
    v_exp_f32 v44, v44
    v_exp_f32 v45, v45
    v_smfmac_f32_16x16x64_bf16 v[88:91], v[92:95], v[32:39], v113
    v_exp_f32 v46, v46
    v_exp_f32 v47, v47
    s_setprio 1
    v_exp_f32 v48, v48
    s_waitcnt lgkmcnt(1)
    v_smfmac_f32_32x32x32_bf16 v[72:87], v[108:111], v[40:47], v113
    ds_read_b128 v[108:111], v1 offset:23552
    v_exp_f32 v49, v49
    v_exp_f32 v50, v50
    v_exp_f32 v51, v51
    v_smfmac_f32_16x16x64_bf16 v[88:91], v[92:95], v[40:47], v113
    v_exp_f32 v52, v52
    v_mfma_f32_32x32x16_bf16 v[32:47], v[96:99], v[8:11], v[16:31]
    ds_read_b128 v[96:99], v1 offset:20480
    v_exp_f32 v53, v53
    v_exp_f32 v54, v54
    v_exp_f32 v55, v55
    v_mfma_f32_32x32x16_bf16 v[32:47], v[100:103], v[12:15], v[32:47]
    ds_read_b128 v[100:103], v1 offset:21504
    v_exp_f32 v56, v56
    v_exp_f32 v57, v57
    v_exp_f32 v58, v58
    s_waitcnt lgkmcnt(3)
    v_smfmac_f32_32x32x32_bf16 v[72:87], v[104:107], v[48:55], v113
    ds_read_b128 v[104:107], v1 offset:22528
    v_exp_f32 v59, v59
    v_exp_f32 v60, v60
    v_exp_f32 v61, v61
    v_smfmac_f32_16x16x64_bf16 v[88:91], v[92:95], v[48:55], v113
    v_exp_f32 v62, v62
    v_exp_f32 v63, v63
    v_exp_f32 v32, v32
    s_waitcnt lgkmcnt(1)
    v_smfmac_f32_32x32x32_bf16 v[72:87], v[108:111], v[56:63], v113
    ds_read_b128 v[108:111], v1 offset:27648
    v_exp_f32 v33, v33
    v_exp_f32 v34, v34
    v_exp_f32 v35, v35
    v_smfmac_f32_16x16x64_bf16 v[88:91], v[92:95], v[56:63], v113
    v_exp_f32 v36, v36
    v_mfma_f32_32x32x16_bf16 v[48:63], v[96:99], v[8:11], v[16:31]
    ds_read_b128 v[96:99], v1 offset:24576
    v_exp_f32 v37, v37
    v_exp_f32 v38, v38
    v_exp_f32 v39, v39
    v_mfma_f32_32x32x16_bf16 v[48:63], v[100:103], v[12:15], v[48:63]
    ds_read_b128 v[100:103], v1 offset:25600
    v_exp_f32 v40, v40
    v_exp_f32 v41, v41
    v_exp_f32 v42, v42
    s_waitcnt lgkmcnt(3)
    v_smfmac_f32_32x32x32_bf16 v[72:87], v[104:107], v[32:39], v113
    ds_read_b128 v[104:107], v1 offset:26624
    v_exp_f32 v43, v43
    v_exp_f32 v44, v44
    v_exp_f32 v45, v45
    v_smfmac_f32_16x16x64_bf16 v[88:91], v[92:95], v[32:39], v113
    v_exp_f32 v46, v46
    v_exp_f32 v47, v47
    s_setprio 0
    v_exp_f32 v48, v48
    s_waitcnt lgkmcnt(1)
    v_smfmac_f32_32x32x32_bf16 v[72:87], v[108:111], v[40:47], v113
    ds_read_b128 v[108:111], v1 offset:31744
    v_exp_f32 v49, v49
    v_exp_f32 v50, v50
    v_exp_f32 v51, v51
    v_smfmac_f32_16x16x64_bf16 v[88:91], v[92:95], v[40:47], v113
    v_exp_f32 v52, v52
    v_mfma_f32_32x32x16_bf16 v[32:47], v[96:99], v[8:11], v[16:31]
    ds_read_b128 v[96:99], v1 offset:28672
    v_exp_f32 v53, v53
    v_exp_f32 v54, v54
    v_exp_f32 v55, v55
    v_mfma_f32_32x32x16_bf16 v[32:47], v[100:103], v[12:15], v[32:47]
    ds_read_b128 v[100:103], v1 offset:29696
    v_exp_f32 v56, v56
    v_exp_f32 v57, v57
    v_exp_f32 v58, v58
    s_waitcnt lgkmcnt(3)
    v_smfmac_f32_32x32x32_bf16 v[72:87], v[104:107], v[48:55], v113
    ds_read_b128 v[104:107], v1 offset:30720
    v_exp_f32 v59, v59
    v_exp_f32 v60, v60
    v_exp_f32 v61, v61
    v_smfmac_f32_16x16x64_bf16 v[88:91], v[92:95], v[48:55], v113
    v_exp_f32 v62, v62
    v_exp_f32 v63, v63
    s_waitcnt lgkmcnt(0)
    s_barrier
    v_xor_b32 v1, 0x38000, v1
    s_setprio 2
    v_exp_f32 v32, v32
    v_smfmac_f32_32x32x32_bf16 v[72:87], v[108:111], v[56:63], v113
    ds_read_b128 v[108:111], v1 offset:3072
    v_exp_f32 v33, v33
    v_exp_f32 v34, v34
    v_exp_f32 v35, v35
    v_smfmac_f32_16x16x64_bf16 v[88:91], v[92:95], v[56:63], v113
    v_exp_f32 v36, v36
    v_mfma_f32_32x32x16_bf16 v[48:63], v[96:99], v[8:11], v[16:31]
    ds_read_b128 v[96:99], v1 offset:0
    v_exp_f32 v37, v37
    v_exp_f32 v38, v38
    v_exp_f32 v39, v39
    v_mfma_f32_32x32x16_bf16 v[48:63], v[100:103], v[12:15], v[48:63]
    ds_read_b128 v[100:103], v1 offset:1024
    v_exp_f32 v40, v40
    v_exp_f32 v41, v41
    v_exp_f32 v42, v42
    s_waitcnt lgkmcnt(3)
    v_smfmac_f32_32x32x32_bf16 v[72:87], v[104:107], v[32:39], v113
    ds_read_b128 v[104:107], v1 offset:2048
    v_exp_f32 v43, v43
    v_exp_f32 v44, v44
    v_exp_f32 v45, v45
    v_smfmac_f32_16x16x64_bf16 v[88:91], v[92:95], v[32:39], v113
    v_exp_f32 v46, v46
    v_exp_f32 v47, v47
    v_exp_f32 v48, v48
    s_waitcnt lgkmcnt(1)
    v_smfmac_f32_32x32x32_bf16 v[72:87], v[108:111], v[40:47], v113
    ds_read_b128 v[108:111], v1 offset:7168
    v_exp_f32 v49, v49
    v_exp_f32 v50, v50
    v_exp_f32 v51, v51
    v_smfmac_f32_16x16x64_bf16 v[88:91], v[92:95], v[40:47], v113
    v_exp_f32 v52, v52
    v_mfma_f32_32x32x16_bf16 v[32:47], v[96:99], v[8:11], v[16:31]
    ds_read_b128 v[96:99], v1 offset:4096
    v_exp_f32 v53, v53
    v_exp_f32 v54, v54
    v_exp_f32 v55, v55
    v_mfma_f32_32x32x16_bf16 v[32:47], v[100:103], v[12:15], v[32:47]
    ds_read_b128 v[100:103], v1 offset:5120
    v_exp_f32 v56, v56
    v_exp_f32 v57, v57
    v_exp_f32 v58, v58
    s_waitcnt lgkmcnt(3)
    v_smfmac_f32_32x32x32_bf16 v[72:87], v[104:107], v[48:55], v113
    ds_read_b128 v[104:107], v1 offset:6144
    v_exp_f32 v59, v59
    v_exp_f32 v60, v60
    v_exp_f32 v61, v61
    v_smfmac_f32_16x16x64_bf16 v[88:91], v[92:95], v[48:55], v113
    v_exp_f32 v62, v62
    v_exp_f32 v63, v63
    s_add_u32 s67, s67, 1
    s_cmp_lt_u32 s67, 8
    s_cbranch_scc1 C_AL
    s_mov_b32 s67, 0
    v_smfmac_f32_16x16x64_bf16 v[88:91], v[92:95], v[56:63], v113
    s_waitcnt lgkmcnt(0)
    v_smfmac_f32_32x32x32_bf16 v[72:87], v[108:111], v[56:63], v113
C_FIN:
    s_nop 5
    v_mov_b32 v89, v88
    s_nop 1
    v_permlane32_swap_b32 v88, v89
    v_rcp_f32 v6, v88
    s_nop 0
    v_mul_f32 v72, v72, v6
    v_mul_f32 v73, v73, v6
    v_mul_f32 v74, v74, v6
    v_mul_f32 v75, v75, v6
    v_mul_f32 v76, v76, v6
    v_mul_f32 v77, v77, v6
    v_mul_f32 v78, v78, v6
    v_mul_f32 v79, v79, v6
    v_cvt_pk_bf16_f32 v64, v72, v73
    v_cvt_pk_bf16_f32 v65, v74, v75
    v_cvt_pk_bf16_f32 v66, v76, v77
    v_cvt_pk_bf16_f32 v67, v78, v79
    buffer_store_dwordx4 v[64:67], v2, s[20:23], s72 offen offset:0 sc1
    v_mul_f32 v80, v80, v6
    v_mul_f32 v81, v81, v6
    v_mul_f32 v82, v82, v6
    v_mul_f32 v83, v83, v6
    v_mul_f32 v84, v84, v6
    v_mul_f32 v85, v85, v6
    v_mul_f32 v86, v86, v6
    v_mul_f32 v87, v87, v6
    v_cvt_pk_bf16_f32 v68, v80, v81
    v_cvt_pk_bf16_f32 v69, v82, v83
    v_cvt_pk_bf16_f32 v70, v84, v85
    v_cvt_pk_bf16_f32 v71, v86, v87
    buffer_store_dwordx4 v[68:71], v2, s[20:23], s72 offen offset:1024 sc1
    s_cmp_lg_u32 s67, 0
    s_cbranch_scc1 C_CHKD
    v_add_f32 v6, abs(v72), abs(v73)
    v_add_f32 v6, v6, abs(v74)
    v_add_f32 v6, v6, abs(v75)
    v_add_f32 v6, v6, abs(v76)
    v_add_f32 v6, v6, abs(v77)
    v_add_f32 v6, v6, abs(v78)
    v_add_f32 v6, v6, abs(v79)
    v_add_f32 v6, v6, abs(v80)
    v_add_f32 v6, v6, abs(v81)
    v_add_f32 v6, v6, abs(v82)
    v_add_f32 v6, v6, abs(v83)
    v_add_f32 v6, v6, abs(v84)
    v_add_f32 v6, v6, abs(v85)
    v_add_f32 v6, v6, abs(v86)
    v_add_f32 v6, v6, abs(v87)
    v_mov_b32 v32, 0x5d800000
    v_cmp_nlt_f32 vcc, v88, v32
    s_nop 0
    s_mov_b64 s[60:61], vcc
    v_mov_b32 v32, 0x7f000000
    v_cmp_nlt_f32 vcc, v6, v32
    s_nop 0
    s_or_b64 s[60:61], s[60:61], vcc
    s_cmp_lg_u64 s[60:61], 0
    s_cbranch_scc1 C_SLOW
C_CHKD:
    s_cmp_eq_u32 s74, 0
    s_cbranch_scc1 C_NOW
    s_and_b32 s61, s56, 1
    s_lshl_b32 s61, s61, 11
    v_add_u32 v8, s61, v5
    ds_write_b128 v8, v[64:67] offset:40960
    ds_write_b128 v8, v[68:71] offset:41984
C_NOW:
    v_mov_b32 v8, 0
    v_mov_b32 v9, 0x40000000
    v_cmp_gt_u32 vcc, 1, v0
    s_nop 1
    v_cndmask_b32 v8, v9, v8, vcc
    v_mov_b32 v9, s52
    v_add_u32 v11, 65536, v4
    v_add_u32 v12, 147456, v4
    s_lshl_b32 s54, s5, 1
    s_waitcnt vmcnt(0)
    buffer_store_dword v9, v8, s[20:23], s73 offen sc1
    s_cmp_eq_u32 s74, 1
    s_cbranch_scc1 C_B11
    s_barrier
    s_barrier
C_B11:
    s_cmp_eq_u32 s74, 0
    s_cselect_b64 vcc, -1, 0
    s_waitcnt lgkmcnt(0)
    s_barrier
    ds_read_b128 v[32:35], v5 offset:0
    ds_read_b64_tr_b16 v[48:49], v4 offset:0
    ds_read_b64_tr_b16 v[50:51], v4 offset:2048
    ds_read_b128 v[36:39], v5 offset:1024
    ds_read_b64_tr_b16 v[52:53], v4 offset:4096
    ds_read_b64_tr_b16 v[54:55], v4 offset:6144
    ds_read_b128 v[40:43], v5 offset:2048
    ds_read_b64_tr_b16 v[56:57], v4 offset:8192
    ds_read_b64_tr_b16 v[58:59], v4 offset:10240
    ds_read_b128 v[44:47], v5 offset:3072
    ds_read_b64_tr_b16 v[60:61], v4 offset:12288
    ds_read_b64_tr_b16 v[62:63], v4 offset:14336
    ds_read_b128 v[64:67], v5 offset:16384
    ds_read_b64_tr_b16 v[80:81], v4 offset:16384
    ds_read_b64_tr_b16 v[82:83], v4 offset:18432
    ds_read_b128 v[68:71], v5 offset:17408
    ds_read_b64_tr_b16 v[84:85], v4 offset:20480
    ds_read_b64_tr_b16 v[86:87], v4 offset:22528
    ds_read_b128 v[72:75], v5 offset:18432
    ds_read_b64_tr_b16 v[88:89], v4 offset:24576
    ds_read_b64_tr_b16 v[90:91], v4 offset:26624
    ds_read_b128 v[76:79], v5 offset:19456
    ds_read_b64_tr_b16 v[92:93], v4 offset:28672
    ds_read_b64_tr_b16 v[94:95], v4 offset:30720
    s_waitcnt lgkmcnt(12)
    s_barrier
    v_mfma_f32_32x32x16_bf16 v[16:31], v[48:51], v[32:35], 0
    ds_read_b128 v[96:99], v5 offset:24576
    ds_read_b64_tr_b16 v[112:113], v4 offset:32768
    ds_read_b64_tr_b16 v[114:115], v4 offset:34816
    v_mfma_f32_32x32x16_bf16 v[16:31], v[52:55], v[36:39], v[16:31]
    ds_read_b128 v[100:103], v5 offset:25600
    ds_read_b64_tr_b16 v[116:117], v4 offset:36864
    ds_read_b64_tr_b16 v[118:119], v4 offset:38912
    v_mfma_f32_32x32x16_bf16 v[16:31], v[56:59], v[40:43], v[16:31]
    ds_read_b128 v[104:107], v5 offset:26624
    ds_read_b64_tr_b16 v[120:121], v4 offset:40960
    ds_read_b64_tr_b16 v[122:123], v4 offset:43008
    v_mfma_f32_32x32x16_bf16 v[16:31], v[60:63], v[44:47], v[16:31]
    ds_read_b128 v[108:111], v5 offset:27648
    ds_read_b64_tr_b16 v[124:125], v4 offset:45056
    ds_read_b64_tr_b16 v[126:127], v4 offset:47104
    s_waitcnt lgkmcnt(12)
    s_barrier
    v_mfma_f32_32x32x16_bf16 v[16:31], v[80:83], v[64:67], v[16:31]
    ds_read_b128 v[128:131], v5 offset:32768
    ds_read_b64_tr_b16 v[144:145], v4 offset:49152
    ds_read_b64_tr_b16 v[146:147], v4 offset:51200
    v_mfma_f32_32x32x16_bf16 v[16:31], v[84:87], v[68:71], v[16:31]
    ds_read_b128 v[132:135], v5 offset:33792
    ds_read_b64_tr_b16 v[148:149], v4 offset:53248
    ds_read_b64_tr_b16 v[150:151], v4 offset:55296
    v_mfma_f32_32x32x16_bf16 v[16:31], v[88:91], v[72:75], v[16:31]
    ds_read_b128 v[136:139], v5 offset:34816
    ds_read_b64_tr_b16 v[152:153], v4 offset:57344
    ds_read_b64_tr_b16 v[154:155], v4 offset:59392
    v_mfma_f32_32x32x16_bf16 v[16:31], v[92:95], v[76:79], v[16:31]
    ds_read_b128 v[140:143], v5 offset:35840
    ds_read_b64_tr_b16 v[156:157], v4 offset:61440
    ds_read_b64_tr_b16 v[158:159], v4 offset:63488
    s_waitcnt lgkmcnt(12)
    s_barrier
    v_mfma_f32_32x32x16_bf16 v[16:31], v[112:115], v[96:99], v[16:31]
    ds_read_b128 v[32:35], v5 offset:49152
    ds_read_b64_tr_b16 v[48:49], v11 offset:0
    ds_read_b64_tr_b16 v[50:51], v11 offset:2048
    v_mfma_f32_32x32x16_bf16 v[16:31], v[116:119], v[100:103], v[16:31]
    ds_read_b128 v[36:39], v5 offset:50176
    ds_read_b64_tr_b16 v[52:53], v11 offset:4096
    ds_read_b64_tr_b16 v[54:55], v11 offset:6144
    v_mfma_f32_32x32x16_bf16 v[16:31], v[120:123], v[104:107], v[16:31]
    ds_read_b128 v[40:43], v5 offset:51200
    ds_read_b64_tr_b16 v[56:57], v11 offset:8192
    ds_read_b64_tr_b16 v[58:59], v11 offset:10240
    v_mfma_f32_32x32x16_bf16 v[16:31], v[124:127], v[108:111], v[16:31]
    ds_read_b128 v[44:47], v5 offset:52224
    ds_read_b64_tr_b16 v[60:61], v11 offset:12288
    ds_read_b64_tr_b16 v[62:63], v11 offset:14336
    s_waitcnt lgkmcnt(12)
    s_barrier
    v_mfma_f32_32x32x16_bf16 v[16:31], v[144:147], v[128:131], v[16:31]
    ds_read_b128 v[64:67], v5 offset:57344
    ds_read_b64_tr_b16 v[80:81], v12 offset:0
    ds_read_b64_tr_b16 v[82:83], v12 offset:2048
    v_mfma_f32_32x32x16_bf16 v[16:31], v[148:151], v[132:135], v[16:31]
    ds_read_b128 v[68:71], v5 offset:58368
    ds_read_b64_tr_b16 v[84:85], v12 offset:4096
    ds_read_b64_tr_b16 v[86:87], v12 offset:6144
    v_mfma_f32_32x32x16_bf16 v[16:31], v[152:155], v[136:139], v[16:31]
    ds_read_b128 v[72:75], v5 offset:59392
    ds_read_b64_tr_b16 v[88:89], v12 offset:8192
    ds_read_b64_tr_b16 v[90:91], v12 offset:10240
    v_mfma_f32_32x32x16_bf16 v[16:31], v[156:159], v[140:143], v[16:31]
    ds_read_b128 v[76:79], v5 offset:60416
    ds_read_b64_tr_b16 v[92:93], v12 offset:12288
    ds_read_b64_tr_b16 v[94:95], v12 offset:14336
    s_waitcnt lgkmcnt(12)
    s_barrier
    v_mfma_f32_32x32x16_bf16 v[16:31], v[48:51], v[32:35], v[16:31]
    ds_read_b128 v[96:99], v5 offset:0
    ds_read_b64_tr_b16 v[112:113], v4 offset:0
    ds_read_b64_tr_b16 v[114:115], v4 offset:2048
    v_mfma_f32_32x32x16_bf16 v[16:31], v[52:55], v[36:39], v[16:31]
    ds_read_b128 v[100:103], v5 offset:1024
    ds_read_b64_tr_b16 v[116:117], v4 offset:4096
    ds_read_b64_tr_b16 v[118:119], v4 offset:6144
    v_mfma_f32_32x32x16_bf16 v[16:31], v[56:59], v[40:43], v[16:31]
    ds_read_b128 v[104:107], v5 offset:2048
    ds_read_b64_tr_b16 v[120:121], v4 offset:8192
    ds_read_b64_tr_b16 v[122:123], v4 offset:10240
    v_mfma_f32_32x32x16_bf16 v[16:31], v[60:63], v[44:47], v[16:31]
    ds_read_b128 v[108:111], v5 offset:3072
    ds_read_b64_tr_b16 v[124:125], v4 offset:12288
    ds_read_b64_tr_b16 v[126:127], v4 offset:14336
    s_waitcnt lgkmcnt(12)
    s_barrier
    v_mfma_f32_32x32x16_bf16 v[16:31], v[80:83], v[64:67], v[16:31]
    ds_read_b128 v[128:131], v5 offset:16384
    ds_read_b64_tr_b16 v[144:145], v4 offset:16384
    ds_read_b64_tr_b16 v[146:147], v4 offset:18432
    v_mfma_f32_32x32x16_bf16 v[16:31], v[84:87], v[68:71], v[16:31]
    ds_read_b128 v[132:135], v5 offset:17408
    ds_read_b64_tr_b16 v[148:149], v4 offset:20480
    ds_read_b64_tr_b16 v[150:151], v4 offset:22528
    v_mfma_f32_32x32x16_bf16 v[16:31], v[88:91], v[72:75], v[16:31]
    ds_read_b128 v[136:139], v5 offset:18432
    ds_read_b64_tr_b16 v[152:153], v4 offset:24576
    ds_read_b64_tr_b16 v[154:155], v4 offset:26624
    v_mfma_f32_32x32x16_bf16 v[16:31], v[92:95], v[76:79], v[16:31]
    ds_read_b128 v[140:143], v5 offset:19456
    ds_read_b64_tr_b16 v[156:157], v4 offset:28672
    ds_read_b64_tr_b16 v[158:159], v4 offset:30720
    s_waitcnt lgkmcnt(12)
    s_barrier
    v_mfma_f32_32x32x16_bf16 v[16:31], v[112:115], v[96:99], v[16:31]
    ds_read_b128 v[32:35], v5 offset:40960
    ds_read_b64_tr_b16 v[48:49], v4 offset:32768
    ds_read_b64_tr_b16 v[50:51], v4 offset:34816
    v_mfma_f32_32x32x16_bf16 v[16:31], v[116:119], v[100:103], v[16:31]
    ds_read_b128 v[36:39], v5 offset:41984
    ds_read_b64_tr_b16 v[52:53], v4 offset:36864
    ds_read_b64_tr_b16 v[54:55], v4 offset:38912
    v_mfma_f32_32x32x16_bf16 v[16:31], v[120:123], v[104:107], v[16:31]
    ds_read_b128 v[40:43], v5 offset:43008
    ds_read_b64_tr_b16 v[56:57], v4 offset:40960
    ds_read_b64_tr_b16 v[58:59], v4 offset:43008
    v_mfma_f32_32x32x16_bf16 v[16:31], v[124:127], v[108:111], v[16:31]
    ds_read_b128 v[44:47], v5 offset:44032
    ds_read_b64_tr_b16 v[60:61], v4 offset:45056
    ds_read_b64_tr_b16 v[62:63], v4 offset:47104
    s_waitcnt lgkmcnt(12)
    v_mfma_f32_32x32x16_bf16 v[16:31], v[144:147], v[128:131], v[16:31]
    v_mfma_f32_32x32x16_bf16 v[16:31], v[148:151], v[132:135], v[16:31]
    v_mfma_f32_32x32x16_bf16 v[16:31], v[152:155], v[136:139], v[16:31]
    v_mfma_f32_32x32x16_bf16 v[16:31], v[156:159], v[140:143], v[16:31]
    s_waitcnt lgkmcnt(0)
    v_mfma_f32_32x32x16_bf16 v[16:31], v[48:51], v[32:35], v[16:31]
    v_mfma_f32_32x32x16_bf16 v[16:31], v[52:55], v[36:39], v[16:31]
    v_mfma_f32_32x32x16_bf16 v[16:31], v[56:59], v[40:43], v[16:31]
    v_mfma_f32_32x32x16_bf16 v[16:31], v[60:63], v[44:47], v[16:31]
    v_and_b32 v8, 31, v0
    s_lshl_b32 s60, s55, 5
    v_add_u32 v8, s60, v8
    v_lshlrev_b32 v9, 2, v8
    v_add_u32 v9, 93696, v9
    s_lshl_b32 s60, s56, 2
    v_add_u32 v13, s60, v3
    v_and_b32 v14, 15, v8
    v_xor_b32 v13, v13, v14
    v_lshlrev_b32 v13, 4, v13
    v_lshl_add_u32 v13, v8, 8, v13
    v_xor_b32 v14, 32, v13
    v_lshrrev_b32 v10, 4, v0
    s_lshl_b32 s60, s3, 3
    v_add_u32 v10, s60, v10
    v_and_b32 v15, 15, v0
    v_lshlrev_b32 v7, 4, v15
    v_lshl_add_u32 v7, v10, 11, v7
    v_and_b32 v1, 15, v10
    v_xor_b32 v15, v15, v1
    v_lshlrev_b32 v15, 4, v15
    v_lshl_add_u32 v15, v10, 8, v15
    v_xor_b32 v10, 64, v15
    s_lshl_b32 s70, s4, 17
    s_lshl_b32 s60, s5, 8
    s_add_u32 s70, s70, s60
    s_add_u32 s71, s70, 8192
    s_cmp_lg_u32 s74, 0
    s_cbranch_scc1 C_D9
    s_waitcnt vmcnt(0)
C_D9:
    s_barrier
    ds_read_b128 v[64:67], v5 offset:24576
    ds_read_b64_tr_b16 v[80:81], v4 offset:49152
    ds_read_b64_tr_b16 v[82:83], v4 offset:51200
    ds_read_b128 v[68:71], v5 offset:25600
    ds_read_b64_tr_b16 v[84:85], v4 offset:53248
    ds_read_b64_tr_b16 v[86:87], v4 offset:55296
    ds_read_b128 v[72:75], v5 offset:26624
    ds_read_b64_tr_b16 v[88:89], v4 offset:57344
    ds_read_b64_tr_b16 v[90:91], v4 offset:59392
    ds_read_b128 v[76:79], v5 offset:27648
    ds_read_b64_tr_b16 v[92:93], v4 offset:61440
    ds_read_b64_tr_b16 v[94:95], v4 offset:63488
    s_barrier
    ds_read_b128 v[96:99], v5 offset:32768
    ds_read_b64_tr_b16 v[112:113], v11 offset:0
    ds_read_b64_tr_b16 v[114:115], v11 offset:2048
    ds_read_b128 v[100:103], v5 offset:33792
    ds_read_b64_tr_b16 v[116:117], v11 offset:4096
    ds_read_b64_tr_b16 v[118:119], v11 offset:6144
    ds_read_b128 v[104:107], v5 offset:34816
    ds_read_b64_tr_b16 v[120:121], v11 offset:8192
    ds_read_b64_tr_b16 v[122:123], v11 offset:10240
    ds_read_b128 v[108:111], v5 offset:35840
    ds_read_b64_tr_b16 v[124:125], v11 offset:12288
    ds_read_b64_tr_b16 v[126:127], v11 offset:14336
    s_waitcnt lgkmcnt(12)
    s_barrier
    v_mfma_f32_32x32x16_bf16 v[16:31], v[80:83], v[64:67], v[16:31]
    ds_read_b128 v[128:131], v5 offset:49152
    ds_read_b64_tr_b16 v[144:145], v12 offset:0
    ds_read_b64_tr_b16 v[146:147], v12 offset:2048
    v_mfma_f32_32x32x16_bf16 v[16:31], v[84:87], v[68:71], v[16:31]
    ds_read_b128 v[132:135], v5 offset:50176
    ds_read_b64_tr_b16 v[148:149], v12 offset:4096
    ds_read_b64_tr_b16 v[150:151], v12 offset:6144
    v_mfma_f32_32x32x16_bf16 v[16:31], v[88:91], v[72:75], v[16:31]
    ds_read_b128 v[136:139], v5 offset:51200
    ds_read_b64_tr_b16 v[152:153], v12 offset:8192
    ds_read_b64_tr_b16 v[154:155], v12 offset:10240
    v_mfma_f32_32x32x16_bf16 v[16:31], v[92:95], v[76:79], v[16:31]
    ds_read_b128 v[140:143], v5 offset:52224
    ds_read_b64_tr_b16 v[156:157], v12 offset:12288
    ds_read_b64_tr_b16 v[158:159], v12 offset:14336
    s_waitcnt lgkmcnt(12)
    s_barrier
    v_mfma_f32_32x32x16_bf16 v[16:31], v[112:115], v[96:99], v[16:31]
    ds_read_b128 v[32:35], v5 offset:57344
    ds_read_b64_tr_b16 v[48:49], v4 offset:0
    ds_read_b64_tr_b16 v[50:51], v4 offset:2048
    v_mfma_f32_32x32x16_bf16 v[16:31], v[116:119], v[100:103], v[16:31]
    ds_read_b128 v[36:39], v5 offset:58368
    ds_read_b64_tr_b16 v[52:53], v4 offset:4096
    ds_read_b64_tr_b16 v[54:55], v4 offset:6144
    v_mfma_f32_32x32x16_bf16 v[16:31], v[120:123], v[104:107], v[16:31]
    ds_read_b128 v[40:43], v5 offset:59392
    ds_read_b64_tr_b16 v[56:57], v4 offset:8192
    ds_read_b64_tr_b16 v[58:59], v4 offset:10240
    v_mfma_f32_32x32x16_bf16 v[16:31], v[124:127], v[108:111], v[16:31]
    ds_read_b128 v[44:47], v5 offset:60416
    ds_read_b64_tr_b16 v[60:61], v4 offset:12288
    ds_read_b64_tr_b16 v[62:63], v4 offset:14336
    s_waitcnt lgkmcnt(12)
    s_barrier
    v_mfma_f32_32x32x16_bf16 v[16:31], v[144:147], v[128:131], v[16:31]
    ds_read_b128 v[64:67], v5 offset:0
    ds_read_b64_tr_b16 v[80:81], v4 offset:16384
    ds_read_b64_tr_b16 v[82:83], v4 offset:18432
    v_mfma_f32_32x32x16_bf16 v[16:31], v[148:151], v[132:135], v[16:31]
    ds_read_b128 v[68:71], v5 offset:1024
    ds_read_b64_tr_b16 v[84:85], v4 offset:20480
    ds_read_b64_tr_b16 v[86:87], v4 offset:22528
    v_mfma_f32_32x32x16_bf16 v[16:31], v[152:155], v[136:139], v[16:31]
    ds_read_b128 v[72:75], v5 offset:2048
    ds_read_b64_tr_b16 v[88:89], v4 offset:24576
    ds_read_b64_tr_b16 v[90:91], v4 offset:26624
    v_mfma_f32_32x32x16_bf16 v[16:31], v[156:159], v[140:143], v[16:31]
    ds_read_b128 v[76:79], v5 offset:3072
    ds_read_b64_tr_b16 v[92:93], v4 offset:28672
    ds_read_b64_tr_b16 v[94:95], v4 offset:30720
    s_waitcnt lgkmcnt(12)
    s_barrier
    v_mfma_f32_32x32x16_bf16 v[16:31], v[48:51], v[32:35], v[16:31]
    ds_read_b128 v[96:99], v5 offset:16384
    ds_read_b64_tr_b16 v[112:113], v4 offset:32768
    ds_read_b64_tr_b16 v[114:115], v4 offset:34816
    v_mfma_f32_32x32x16_bf16 v[16:31], v[52:55], v[36:39], v[16:31]
    ds_read_b128 v[100:103], v5 offset:17408
    ds_read_b64_tr_b16 v[116:117], v4 offset:36864
    ds_read_b64_tr_b16 v[118:119], v4 offset:38912
    v_mfma_f32_32x32x16_bf16 v[16:31], v[56:59], v[40:43], v[16:31]
    ds_read_b128 v[104:107], v5 offset:18432
    ds_read_b64_tr_b16 v[120:121], v4 offset:40960
    ds_read_b64_tr_b16 v[122:123], v4 offset:43008
    v_mfma_f32_32x32x16_bf16 v[16:31], v[60:63], v[44:47], v[16:31]
    ds_read_b128 v[108:111], v5 offset:19456
    ds_read_b64_tr_b16 v[124:125], v4 offset:45056
    ds_read_b64_tr_b16 v[126:127], v4 offset:47104
    s_waitcnt lgkmcnt(12)
    s_barrier
    v_mfma_f32_32x32x16_bf16 v[16:31], v[80:83], v[64:67], v[16:31]
    ds_read_b128 v[128:131], v5 offset:40960
    ds_read_b64_tr_b16 v[144:145], v4 offset:49152
    ds_read_b64_tr_b16 v[146:147], v4 offset:51200
    v_mfma_f32_32x32x16_bf16 v[16:31], v[84:87], v[68:71], v[16:31]
    ds_read_b128 v[132:135], v5 offset:41984
    ds_read_b64_tr_b16 v[148:149], v4 offset:53248
    ds_read_b64_tr_b16 v[150:151], v4 offset:55296
    v_mfma_f32_32x32x16_bf16 v[16:31], v[88:91], v[72:75], v[16:31]
    ds_read_b128 v[136:139], v5 offset:43008
    ds_read_b64_tr_b16 v[152:153], v4 offset:57344
    ds_read_b64_tr_b16 v[154:155], v4 offset:59392
    v_mfma_f32_32x32x16_bf16 v[16:31], v[92:95], v[76:79], v[16:31]
    ds_read_b128 v[140:143], v5 offset:44032
    ds_read_b64_tr_b16 v[156:157], v4 offset:61440
    ds_read_b64_tr_b16 v[158:159], v4 offset:63488
    s_waitcnt lgkmcnt(12)
    v_mfma_f32_32x32x16_bf16 v[16:31], v[112:115], v[96:99], v[16:31]
    v_mfma_f32_32x32x16_bf16 v[16:31], v[116:119], v[100:103], v[16:31]
    v_mfma_f32_32x32x16_bf16 v[16:31], v[120:123], v[104:107], v[16:31]
    v_mfma_f32_32x32x16_bf16 v[16:31], v[124:127], v[108:111], v[16:31]
    s_waitcnt lgkmcnt(0)
    v_mfma_f32_32x32x16_bf16 v[16:31], v[144:147], v[128:131], v[16:31]
    v_mfma_f32_32x32x16_bf16 v[16:31], v[148:151], v[132:135], v[16:31]
    v_mfma_f32_32x32x16_bf16 v[16:31], v[152:155], v[136:139], v[16:31]
    v_mfma_f32_32x32x16_bf16 v[16:31], v[156:159], v[140:143], v[16:31]
    ds_read_b32 v32, v9
    ds_read_b32 v33, v9 offset:256
    v_lshlrev_b32 v44, 16, v160
    v_and_b32 v45, 0xffff0000, v160
    v_lshlrev_b32 v46, 16, v161
    v_and_b32 v47, 0xffff0000, v161
    v_lshlrev_b32 v48, 16, v162
    v_and_b32 v49, 0xffff0000, v162
    v_lshlrev_b32 v50, 16, v163
    v_and_b32 v51, 0xffff0000, v163
    v_lshlrev_b32 v52, 16, v164
    v_and_b32 v53, 0xffff0000, v164
    v_lshlrev_b32 v54, 16, v165
    v_and_b32 v55, 0xffff0000, v165
    v_lshlrev_b32 v56, 16, v166
    v_and_b32 v57, 0xffff0000, v166
    v_lshlrev_b32 v58, 16, v167
    v_and_b32 v59, 0xffff0000, v167
    s_waitcnt lgkmcnt(0)
    v_cmp_ne_u32 vcc, -1, v33
    s_cbranch_vccz C_NOSEL
    v_and_b32 v11, 7, v33
    v_lshlrev_b32 v11, 9, v11
    v_lshl_add_u32 v11, v3, 5, v11
    s_lshl_b32 s60, s56, 7
    s_add_u32 s60, s60, 94208
    v_add_u32 v11, s60, v11
    ds_read_b128 v[64:67], v11 offset:0
    ds_read_b128 v[68:71], v11 offset:16
    ds_read_b128 v[72:75], v11 offset:64
    ds_read_b128 v[76:79], v11 offset:80
    s_waitcnt lgkmcnt(0)
    v_add_f32 v64, v64, v44
    v_cndmask_b32 v44, v44, v64, vcc
    v_add_f32 v65, v65, v45
    v_cndmask_b32 v45, v45, v65, vcc
    v_add_f32 v66, v66, v46
    v_cndmask_b32 v46, v46, v66, vcc
    v_add_f32 v67, v67, v47
    v_cndmask_b32 v47, v47, v67, vcc
    v_add_f32 v68, v68, v48
    v_cndmask_b32 v48, v48, v68, vcc
    v_add_f32 v69, v69, v49
    v_cndmask_b32 v49, v49, v69, vcc
    v_add_f32 v70, v70, v50
    v_cndmask_b32 v50, v50, v70, vcc
    v_add_f32 v71, v71, v51
    v_cndmask_b32 v51, v51, v71, vcc
    v_add_f32 v72, v72, v52
    v_cndmask_b32 v52, v52, v72, vcc
    v_add_f32 v73, v73, v53
    v_cndmask_b32 v53, v53, v73, vcc
    v_add_f32 v74, v74, v54
    v_cndmask_b32 v54, v54, v74, vcc
    v_add_f32 v75, v75, v55
    v_cndmask_b32 v55, v55, v75, vcc
    v_add_f32 v76, v76, v56
    v_cndmask_b32 v56, v56, v76, vcc
    v_add_f32 v77, v77, v57
    v_cndmask_b32 v57, v57, v77, vcc
    v_add_f32 v78, v78, v58
    v_cndmask_b32 v58, v58, v78, vcc
    v_add_f32 v79, v79, v59
    v_cndmask_b32 v59, v59, v79, vcc
C_NOSEL:
    v_sub_f32 v34, 1.0, v32
    v_mul_f32 v44, v34, v44
    v_mul_f32 v45, v34, v45
    v_mul_f32 v46, v34, v46
    v_mul_f32 v47, v34, v47
    v_mul_f32 v48, v34, v48
    v_mul_f32 v49, v34, v49
    v_mul_f32 v50, v34, v50
    v_mul_f32 v51, v34, v51
    v_mul_f32 v52, v34, v52
    v_mul_f32 v53, v34, v53
    v_mul_f32 v54, v34, v54
    v_mul_f32 v55, v34, v55
    v_mul_f32 v56, v34, v56
    v_mul_f32 v57, v34, v57
    v_mul_f32 v58, v34, v58
    v_mul_f32 v59, v34, v59
    v_fma_f32 v44, v32, v16, v44
    v_fma_f32 v45, v32, v17, v45
    v_fma_f32 v46, v32, v18, v46
    v_fma_f32 v47, v32, v19, v47
    v_fma_f32 v48, v32, v20, v48
    v_fma_f32 v49, v32, v21, v49
    v_fma_f32 v50, v32, v22, v50
    v_fma_f32 v51, v32, v23, v51
    v_fma_f32 v52, v32, v24, v52
    v_fma_f32 v53, v32, v25, v53
    v_fma_f32 v54, v32, v26, v54
    v_fma_f32 v55, v32, v27, v55
    v_fma_f32 v56, v32, v28, v56
    v_fma_f32 v57, v32, v29, v57
    v_fma_f32 v58, v32, v30, v58
    v_fma_f32 v59, v32, v31, v59
    v_cvt_pk_bf16_f32 v64, v44, v45
    v_cvt_pk_bf16_f32 v65, v46, v47
    v_cvt_pk_bf16_f32 v66, v48, v49
    v_cvt_pk_bf16_f32 v67, v50, v51
    v_cvt_pk_bf16_f32 v68, v52, v53
    v_cvt_pk_bf16_f32 v69, v54, v55
    v_cvt_pk_bf16_f32 v70, v56, v57
    v_cvt_pk_bf16_f32 v71, v58, v59
    ds_write_b128 v13, v[64:67]
    ds_write_b128 v14, v[68:71]
    s_waitcnt lgkmcnt(0)
    s_barrier
    ds_read_b128 v[64:67], v15
    ds_read_b128 v[68:71], v10 offset:1024
    s_waitcnt lgkmcnt(1)
    buffer_store_dwordx4 v[64:67], v7, s[28:31], s70 offen sc1
    s_waitcnt lgkmcnt(0)
    buffer_store_dwordx4 v[68:71], v7, s[28:31], s71 offen sc1
    s_xor_b32 s60, s2, 24
    s_or_b32 s60, s60, s3
    s_cmp_lg_u32 s60, 0
    s_cbranch_scc1 C_DONE
    v_mov_b32 v6, 0
    v_mov_b32 v9, 0x40000000
    v_cmp_gt_u32 vcc, 1, v0
    s_nop 1
    v_cndmask_b32 v6, v9, v6, vcc
    v_mov_b32 v9, s52
    s_mov_b32 s60, 8673280
    buffer_store_dword v9, v6, s[20:23], s60 offen sc1
C_DONE:
    s_endpgm
C_XO1:
    s_bitcmp1_b32 s56, 0
    s_cbranch_scc1 C_XD1
    v_mov_b32 v160, v32
    v_mov_b32 v161, v33
    v_mov_b32 v162, v34
    v_mov_b32 v163, v35
    v_mov_b32 v164, v36
    v_mov_b32 v165, v37
    v_mov_b32 v166, v38
    v_mov_b32 v167, v39
    s_branch C_XC1
C_XD1:
    v_mov_b32 v160, v40
    v_mov_b32 v161, v41
    v_mov_b32 v162, v42
    v_mov_b32 v163, v43
    v_mov_b32 v164, v44
    v_mov_b32 v165, v45
    v_mov_b32 v166, v46
    v_mov_b32 v167, v47
    s_branch C_XC1
C_XO2:
    s_bitcmp1_b32 s56, 0
    s_cbranch_scc1 C_XD2
    v_mov_b32 v160, v64
    v_mov_b32 v161, v65
    v_mov_b32 v162, v66
    v_mov_b32 v163, v67
    v_mov_b32 v164, v68
    v_mov_b32 v165, v69
    v_mov_b32 v166, v70
    v_mov_b32 v167, v71
    s_branch C_XC2
C_XD2:
    v_mov_b32 v160, v72
    v_mov_b32 v161, v73
    v_mov_b32 v162, v74
    v_mov_b32 v163, v75
    v_mov_b32 v164, v76
    v_mov_b32 v165, v77
    v_mov_b32 v166, v78
    v_mov_b32 v167, v79
    s_branch C_XC2
C_XO3:
    s_bitcmp1_b32 s56, 0
    s_cbranch_scc1 C_XD3
    v_mov_b32 v160, v96
    v_mov_b32 v161, v97
    v_mov_b32 v162, v98
    v_mov_b32 v163, v99
    v_mov_b32 v164, v100
    v_mov_b32 v165, v101
    v_mov_b32 v166, v102
    v_mov_b32 v167, v103
    s_branch C_XC3
C_XD3:
    v_mov_b32 v160, v104
    v_mov_b32 v161, v105
    v_mov_b32 v162, v106
    v_mov_b32 v163, v107
    v_mov_b32 v164, v108
    v_mov_b32 v165, v109
    v_mov_b32 v166, v110
    v_mov_b32 v167, v111
    s_branch C_XC3
C_XO4:
    s_bitcmp1_b32 s56, 0
    s_cbranch_scc1 C_XD4
    v_mov_b32 v160, v128
    v_mov_b32 v161, v129
    v_mov_b32 v162, v130
    v_mov_b32 v163, v131
    v_mov_b32 v164, v132
    v_mov_b32 v165, v133
    v_mov_b32 v166, v134
    v_mov_b32 v167, v135
    s_branch C_XC4
C_XD4:
    v_mov_b32 v160, v136
    v_mov_b32 v161, v137
    v_mov_b32 v162, v138
    v_mov_b32 v163, v139
    v_mov_b32 v164, v140
    v_mov_b32 v165, v141
    v_mov_b32 v166, v142
    v_mov_b32 v167, v143
    s_branch C_XC4
C_XO5:
    s_bitcmp1_b32 s56, 0
    s_cbranch_scc1 C_XD5
    v_mov_b32 v160, v32
    v_mov_b32 v161, v33
    v_mov_b32 v162, v34
    v_mov_b32 v163, v35
    v_mov_b32 v164, v36
    v_mov_b32 v165, v37
    v_mov_b32 v166, v38
    v_mov_b32 v167, v39
    s_branch C_XC5
C_XD5:
    v_mov_b32 v160, v40
    v_mov_b32 v161, v41
    v_mov_b32 v162, v42
    v_mov_b32 v163, v43
    v_mov_b32 v164, v44
    v_mov_b32 v165, v45
    v_mov_b32 v166, v46
    v_mov_b32 v167, v47
    s_branch C_XC5
C_XO6:
    s_bitcmp1_b32 s56, 0
    s_cbranch_scc1 C_XD6
    v_mov_b32 v160, v64
    v_mov_b32 v161, v65
    v_mov_b32 v162, v66
    v_mov_b32 v163, v67
    v_mov_b32 v164, v68
    v_mov_b32 v165, v69
    v_mov_b32 v166, v70
    v_mov_b32 v167, v71
    s_branch C_XC6
C_XD6:
    v_mov_b32 v160, v72
    v_mov_b32 v161, v73
    v_mov_b32 v162, v74
    v_mov_b32 v163, v75
    v_mov_b32 v164, v76
    v_mov_b32 v165, v77
    v_mov_b32 v166, v78
    v_mov_b32 v167, v79
    s_branch C_XC6
C_XO7:
    s_bitcmp1_b32 s56, 0
    s_cbranch_scc1 C_XD7
    v_mov_b32 v160, v96
    v_mov_b32 v161, v97
    v_mov_b32 v162, v98
    v_mov_b32 v163, v99
    v_mov_b32 v164, v100
    v_mov_b32 v165, v101
    v_mov_b32 v166, v102
    v_mov_b32 v167, v103
    s_branch C_XC7
C_XD7:
    v_mov_b32 v160, v104
    v_mov_b32 v161, v105
    v_mov_b32 v162, v106
    v_mov_b32 v163, v107
    v_mov_b32 v164, v108
    v_mov_b32 v165, v109
    v_mov_b32 v166, v110
    v_mov_b32 v167, v111
    s_branch C_XC7
C_XO8:
    s_bitcmp1_b32 s56, 0
    s_cbranch_scc1 C_XD8
    v_mov_b32 v160, v128
    v_mov_b32 v161, v129
    v_mov_b32 v162, v130
    v_mov_b32 v163, v131
    v_mov_b32 v164, v132
    v_mov_b32 v165, v133
    v_mov_b32 v166, v134
    v_mov_b32 v167, v135
    s_branch C_XC8
C_XD8:
    v_mov_b32 v160, v136
    v_mov_b32 v161, v137
    v_mov_b32 v162, v138
    v_mov_b32 v163, v139
    v_mov_b32 v164, v140
    v_mov_b32 v165, v141
    v_mov_b32 v166, v142
    v_mov_b32 v167, v143
    s_branch C_XC8
C_PUBF:
    s_and_b32 s60, s3, 6
    s_cmp_lg_u32 s60, 4
    s_cbranch_scc1 C_PUBJ
    v_mov_b32 v1, 0
    v_mov_b32 v5, 0x40000000
    v_cmp_gt_u32 vcc, 1, v0
    s_nop 1
    v_cndmask_b32 v1, v5, v1, vcc
    v_mov_b32 v5, s52
    s_waitcnt vmcnt(0)
    buffer_store_dword v5, v1, s[20:23], s63 offen sc1
    s_mov_b64 vcc, 0
    s_branch C_PUBJ
C_SLOW:
    v_mov_b32 v112, 0xff800000
    v_mov_b32 v72, 0
    v_mov_b32 v73, 0
    v_mov_b32 v74, 0
    v_mov_b32 v75, 0
    v_mov_b32 v76, 0
    v_mov_b32 v77, 0
    v_mov_b32 v78, 0
    v_mov_b32 v79, 0
    v_mov_b32 v80, 0
    v_mov_b32 v81, 0
    v_mov_b32 v82, 0
    v_mov_b32 v83, 0
    v_mov_b32 v84, 0
    v_mov_b32 v85, 0
    v_mov_b32 v86, 0
    v_mov_b32 v87, 0
    v_mov_b32 v88, 0
    v_mov_b32 v89, 0
    v_mov_b32 v90, 0
    v_mov_b32 v91, 0
    s_mov_b32 s67, 0
C_SL:
    s_lshl_b32 s60, s67, 12
    s_add_u32 s61, s60, 4096
    s_and_b32 s61, s61, 0x3ffff
    s_add_u32 s62, s60, 8192
    s_and_b32 s62, s62, 0x3ffff
    s_add_u32 s60, s60, 8388608
    s_add_u32 s61, s61, 8388608
    s_add_u32 s62, s62, 8388608
    buffer_load_dwordx4 v[96:99], v2, s[20:23], s60 offen sc1
    buffer_load_dwordx4 v[100:103], v2, s[20:23], s60 offen offset:1024 sc1
    buffer_load_dwordx4 v[104:107], v2, s[20:23], s61 offen offset:2048 sc1
    buffer_load_dwordx4 v[108:111], v2, s[20:23], s62 offen offset:3072 sc1
    s_waitcnt vmcnt(0)
    v_mfma_f32_32x32x16_bf16 v[32:47], v[96:99], v[8:11], 0
    v_mfma_f32_32x32x16_bf16 v[32:47], v[100:103], v[12:15], v[32:47]
    s_nop 11
    v_max3_f32 v6, v32, v33, v34
    v_max3_f32 v6, v6, v35, v36
    v_max3_f32 v6, v6, v37, v38
    v_max3_f32 v6, v6, v39, v40
    v_max3_f32 v6, v6, v41, v42
    v_max3_f32 v6, v6, v43, v44
    v_max3_f32 v6, v6, v45, v46
    v_max_f32 v6, v6, v47
    v_mov_b32 v114, v6
    s_nop 1
    v_permlane32_swap_b32 v6, v114
    v_max3_f32 v6, v6, v114, v112
    v_sub_f32 v114, v112, v6
    v_exp_f32 v114, v114
    v_mov_b32 v112, v6
    v_mul_f32 v72, v72, v114
    v_mul_f32 v73, v73, v114
    v_mul_f32 v74, v74, v114
    v_mul_f32 v75, v75, v114
    v_mul_f32 v76, v76, v114
    v_mul_f32 v77, v77, v114
    v_mul_f32 v78, v78, v114
    v_mul_f32 v79, v79, v114
    v_mul_f32 v80, v80, v114
    v_mul_f32 v81, v81, v114
    v_mul_f32 v82, v82, v114
    v_mul_f32 v83, v83, v114
    v_mul_f32 v84, v84, v114
    v_mul_f32 v85, v85, v114
    v_mul_f32 v86, v86, v114
    v_mul_f32 v87, v87, v114
    v_mul_f32 v88, v88, v114
    v_mul_f32 v89, v89, v114
    v_mul_f32 v90, v90, v114
    v_mul_f32 v91, v91, v114
    v_sub_f32 v32, v32, v6
    v_exp_f32 v32, v32
    v_sub_f32 v33, v33, v6
    v_exp_f32 v33, v33
    v_sub_f32 v34, v34, v6
    v_exp_f32 v34, v34
    v_sub_f32 v35, v35, v6
    v_exp_f32 v35, v35
    v_sub_f32 v36, v36, v6
    v_exp_f32 v36, v36
    v_sub_f32 v37, v37, v6
    v_exp_f32 v37, v37
    v_sub_f32 v38, v38, v6
    v_exp_f32 v38, v38
    v_sub_f32 v39, v39, v6
    v_exp_f32 v39, v39
    v_sub_f32 v40, v40, v6
    v_exp_f32 v40, v40
    v_sub_f32 v41, v41, v6
    v_exp_f32 v41, v41
    v_sub_f32 v42, v42, v6
    v_exp_f32 v42, v42
    v_sub_f32 v43, v43, v6
    v_exp_f32 v43, v43
    v_sub_f32 v44, v44, v6
    v_exp_f32 v44, v44
    v_sub_f32 v45, v45, v6
    v_exp_f32 v45, v45
    v_sub_f32 v46, v46, v6
    v_exp_f32 v46, v46
    v_sub_f32 v47, v47, v6
    v_exp_f32 v47, v47
    v_smfmac_f32_32x32x32_bf16 v[72:87], v[104:107], v[32:39], v113
    s_nop 0
    v_smfmac_f32_32x32x32_bf16 v[72:87], v[108:111], v[40:47], v113
    v_smfmac_f32_16x16x64_bf16 v[88:91], v[92:95], v[32:39], v113
    v_smfmac_f32_16x16x64_bf16 v[88:91], v[92:95], v[40:47], v113
    s_add_u32 s67, s67, 1
    s_cmp_lt_u32 s67, 64
    s_cbranch_scc1 C_SL
    s_branch C_FIN
H_START:
    s_setprio 3
    s_sub_u32 s55, s3, 8
    v_lshrrev_b32 v3, 4, v0
    v_lshlrev_b32 v4, 2, v3
    v_and_b32 v6, 15, v0
    v_xor_b32 v6, v6, v4
    v_lshlrev_b32 v6, 4, v6
    v_lshl_add_u32 v96, v3, 11, v6
    s_lshl_b32 s60, s55, 15
    s_lshl_b32 s61, s5, 8
    s_add_u32 s60, s60, s61
    v_add_u32 v5, s60, v96
    v_lshrrev_b32 v3, 3, v0
    s_lshl_b32 s60, s55, 3
    v_add_u32 v3, s60, v3
    v_bfe_u32 v4, v3, 1, 3
    v_and_b32 v6, 7, v0
    v_xor_b32 v6, v6, v4
    v_lshlrev_b32 v6, 4, v6
    v_lshl_add_u32 v6, v3, 11, v6
    s_lshl_b32 s60, s4, 1
    s_xor_b32 s61, s6, 1
    s_add_u32 s60, s60, s61
    s_lshl_b32 s60, s60, 16
    v_add_u32 v6, s60, v6
    s_lshl_b32 s56, s55, 12
    s_lshl_b32 s57, s55, 10
    s_lshl_b32 s58, s55, 13
    s_waitcnt lgkmcnt(0)
    s_mul_i32 s52, s52, 0x9e3779b1
    s_add_u32 s52, s52, 0x7f4a7c15
    s_sub_u32 s60, s2, 32
    s_and_b32 s61, s60, 7
    s_lshr_b32 s62, s60, 3
    s_lshr_b32 s63, s62, 2
    s_lshl_b32 s63, s63, 3
    s_add_u32 s63, s63, s61
    s_lshl_b32 s63, s63, 2
    s_and_b32 s62, s62, 3
    s_add_u32 s59, s63, s62
    s_cmp_ge_u32 s2, 32
    s_cselect_b32 s59, s59, 0
    s_cselect_b32 s64, 1, 0
    s_lshr_b32 s69, s59, 3
    s_and_b32 s70, s59, 7
    s_lshr_b32 s71, s4, 3
    s_lshl_b32 s71, s71, 1
    s_add_u32 s71, s71, 1
    v_lshrrev_b32 v3, 3, v0
    v_mul_u32_u24 v7, 7168, v3
    v_and_b32 v3, 2, v3
    v_and_b32 v4, 7, v0
    v_xor_b32 v4, v4, v3
    v_lshlrev_b32 v4, 4, v4
    s_and_b32 s60, s59, 3
    s_lshl_b32 s60, s60, 2
    s_add_u32 s60, s60, s55
    s_mul_i32 s60, s60, 458752
    s_lshr_b32 s61, s59, 2
    s_lshl_b32 s61, s61, 7
    s_add_u32 s60, s60, s61
    v_add_u32 v7, s60, v7
    v_xor_b32 v112, 64, v4
    v_add_u32 v112, v112, v7
    v_add_u32 v7, v7, v4
    s_lshl_b32 s60, s69, 18
    s_lshl_b32 s61, s70, 8
    s_add_u32 s60, s60, s61
    s_lshl_b32 s61, s55, 16
    s_add_u32 s60, s60, s61
    v_add_u32 v96, s60, v96
    v_and_b32 v3, 7, v0
    v_lshlrev_b32 v97, 3, v3
    v_lshlrev_b32 v118, 7, v3
    s_add_u32 s66, s57, 2883584
    v_lshrrev_b32 v4, 4, v0
    v_lshlrev_b32 v98, 4, v4
    v_mul_u32_u24 v113, 272, v3
    v_add_u32 v113, v113, v98
    v_and_b32 v11, 8, v0
    v_cmp_eq_u32 vcc, 0, v11
    v_mov_b32 v11, 0x40000000
    s_nop 0
    v_cndmask_b32 v98, v11, v98, vcc
    v_lshl_add_u32 v107, v3, 12, v98
    v_lshl_add_u32 v100, v3, 8, v98
    v_bfe_u32 v12, v0, 2, 2
    v_lshl_add_u32 v13, v4, 3, v12
    v_and_b32 v14, 3, v0
    v_lshlrev_b32 v14, 3, v14
    v_and_b32 v15, 1, v4
    v_lshlrev_b32 v15, 1, v15
    v_lshrrev_b32 v99, 1, v12
    v_or_b32 v15, v15, v99
    v_xor_b32 v15, s55, v15
    v_lshl_add_u32 v15, v15, 5, v14
    v_lshl_add_u32 v99, v13, 7, v15
    v_xor_b32 v12, s55, v12
    v_lshl_add_u32 v12, v12, 6, v14
    v_lshl_add_u32 v106, v13, 8, v12
    v_add_u32 v106, 65536, v106
    v_lshrrev_b32 v12, 3, v0
    v_lshlrev_b32 v12, 8, v12
    v_lshl_add_u32 v101, v3, 4, v12
    v_lshrrev_b32 v105, 3, v0
    v_mul_u32_u24 v105, 272, v105
    v_add_u32 v105, v105, v97
    s_lshl_b32 s60, s55, 6
    v_add_u32 v105, s60, v105
    v_cmp_eq_u32 vcc, 0, v0
    s_nop 1
    v_cndmask_b32 v102, v11, 0, vcc
    v_mov_b32 v103, s52
    v_lshlrev_b32 v108, 2, v0
    v_lshlrev_b32 v109, 3, v0
    v_and_b32 v104, 6, v0
    v_lshlrev_b32 v104, 1, v104
    v_and_b32 v12, 1, v0
    v_or_b32 v104, v104, v12
    s_lshr_b32 s60, s55, 1
    s_lshl_b32 s60, s60, 4
    s_and_b32 s61, s55, 1
    s_lshl_b32 s61, s61, 1
    s_add_u32 s60, s60, s61
    v_add_u32 v104, s60, v104
    v_lshlrev_b32 v104, 7, v104
    v_lshrrev_b32 v12, 1, v0
    v_lshlrev_b32 v12, 11, v12
    v_and_b32 v13, 1, v0
    v_lshl_add_u32 v110, v13, 7, v12
    s_barrier
    s_add_u32 s65, 0, s54
    s_and_b32 s65, s65, 15
    s_lshl_b32 s60, s65, 17
    s_add_u32 m0, s56, 131072
    s_nop 0
    buffer_load_dwordx4 v5, s[12:15], s60 offen lds
    s_add_u32 m0, m0, 1024
    s_add_u32 s60, s60, 8192
    buffer_load_dwordx4 v5, s[12:15], s60 offen lds
    s_add_u32 m0, m0, 1024
    s_add_u32 s60, s60, 8192
    buffer_load_dwordx4 v5, s[12:15], s60 offen lds
    s_add_u32 m0, m0, 1024
    s_add_u32 s60, s60, 8192
    buffer_load_dwordx4 v5, s[12:15], s60 offen lds
    s_lshl_b32 s60, s65, 7
    s_add_u32 m0, s57, 81920
    s_nop 0
    buffer_load_dwordx4 v6, s[8:11], s60 offen lds
    s_barrier
    s_add_u32 s65, 1, s54
    s_and_b32 s65, s65, 15
    s_lshl_b32 s60, s65, 17
    s_add_u32 m0, s56, 147456
    s_nop 0
    buffer_load_dwordx4 v5, s[12:15], s60 offen lds
    s_add_u32 m0, m0, 1024
    s_add_u32 s60, s60, 8192
    buffer_load_dwordx4 v5, s[12:15], s60 offen lds
    s_add_u32 m0, m0, 1024
    s_add_u32 s60, s60, 8192
    buffer_load_dwordx4 v5, s[12:15], s60 offen lds
    s_add_u32 m0, m0, 1024
    s_add_u32 s60, s60, 8192
    buffer_load_dwordx4 v5, s[12:15], s60 offen lds
    s_lshl_b32 s60, s65, 7
    s_add_u32 m0, s57, 86016
    s_nop 0
    buffer_load_dwordx4 v6, s[8:11], s60 offen lds
    s_waitcnt vmcnt(5)
    s_barrier
    s_add_u32 s65, 2, s54
    s_and_b32 s65, s65, 15
    s_lshl_b32 s60, s65, 17
    s_add_u32 m0, s56, 65536
    s_nop 0
    buffer_load_dwordx4 v5, s[12:15], s60 offen lds
    s_add_u32 m0, m0, 1024
    s_add_u32 s60, s60, 8192
    buffer_load_dwordx4 v5, s[12:15], s60 offen lds
    s_add_u32 m0, m0, 1024
    s_add_u32 s60, s60, 8192
    buffer_load_dwordx4 v5, s[12:15], s60 offen lds
    s_add_u32 m0, m0, 1024
    s_add_u32 s60, s60, 8192
    buffer_load_dwordx4 v5, s[12:15], s60 offen lds
    s_lshl_b32 s60, s65, 7
    s_add_u32 m0, s57, 90112
    s_nop 0
    buffer_load_dwordx4 v6, s[8:11], s60 offen lds
    s_waitcnt vmcnt(5)
    s_barrier
    s_add_u32 s65, 3, s54
    s_and_b32 s65, s65, 15
    s_lshl_b32 s60, s65, 17
    s_add_u32 m0, s56, 98304
    s_nop 0
    buffer_load_dwordx4 v5, s[12:15], s60 offen lds
    s_add_u32 m0, m0, 1024
    s_add_u32 s60, s60, 8192
    buffer_load_dwordx4 v5, s[12:15], s60 offen lds
    s_add_u32 m0, m0, 1024
    s_add_u32 s60, s60, 8192
    buffer_load_dwordx4 v5, s[12:15], s60 offen lds
    s_add_u32 m0, m0, 1024
    s_add_u32 s60, s60, 8192
    buffer_load_dwordx4 v5, s[12:15], s60 offen lds
    s_lshl_b32 s60, s65, 7
    s_add_u32 m0, s57, 94208
    s_nop 0
    buffer_load_dwordx4 v6, s[8:11], s60 offen lds
    s_mov_b32 s67, 4
    s_add_u32 s65, 4, s54
    s_and_b32 s65, s65, 15
    s_lshl_b32 s60, s65, 17
    s_lshl_b32 s61, s65, 7
    s_add_u32 m0, s56, 131072
    s_waitcnt vmcnt(5)
    s_branch H_P2E
H_P2L:
    s_add_u32 s68, s67, 0
    s_add_u32 s65, s68, s54
    s_and_b32 s65, s65, 15
    s_lshl_b32 s60, s65, 17
    s_lshl_b32 s61, s65, 7
    s_add_u32 m0, s56, 131072
    s_waitcnt vmcnt(5)
H_P2E:
    s_barrier
    buffer_load_dwordx4 v5, s[12:15], s60 offen lds
    s_add_u32 m0, m0, 1024
    s_add_u32 s60, s60, 8192
    buffer_load_dwordx4 v5, s[12:15], s60 offen lds
    s_add_u32 m0, m0, 1024
    s_add_u32 s60, s60, 8192
    buffer_load_dwordx4 v5, s[12:15], s60 offen lds
    s_add_u32 m0, m0, 1024
    s_add_u32 s60, s60, 8192
    buffer_load_dwordx4 v5, s[12:15], s60 offen lds
    s_add_u32 m0, s57, 81920
    s_nop 0
    buffer_load_dwordx4 v6, s[8:11], s61 offen lds
    s_add_u32 s68, s67, 1
    s_add_u32 s65, s68, s54
    s_and_b32 s65, s65, 15
    s_lshl_b32 s60, s65, 17
    s_lshl_b32 s61, s65, 7
    s_add_u32 m0, s56, 147456
    s_waitcnt vmcnt(5)
    s_barrier
    buffer_load_dwordx4 v5, s[12:15], s60 offen lds
    s_add_u32 m0, m0, 1024
    s_add_u32 s60, s60, 8192
    buffer_load_dwordx4 v5, s[12:15], s60 offen lds
    s_add_u32 m0, m0, 1024
    s_add_u32 s60, s60, 8192
    buffer_load_dwordx4 v5, s[12:15], s60 offen lds
    s_add_u32 m0, m0, 1024
    s_add_u32 s60, s60, 8192
    buffer_load_dwordx4 v5, s[12:15], s60 offen lds
    s_add_u32 m0, s57, 86016
    s_nop 0
    buffer_load_dwordx4 v6, s[8:11], s61 offen lds
    s_add_u32 s68, s67, 2
    s_add_u32 s65, s68, s54
    s_and_b32 s65, s65, 15
    s_lshl_b32 s60, s65, 17
    s_lshl_b32 s61, s65, 7
    s_add_u32 m0, s56, 65536
    s_waitcnt vmcnt(5)
    s_barrier
    buffer_load_dwordx4 v5, s[12:15], s60 offen lds
    s_add_u32 m0, m0, 1024
    s_add_u32 s60, s60, 8192
    buffer_load_dwordx4 v5, s[12:15], s60 offen lds
    s_add_u32 m0, m0, 1024
    s_add_u32 s60, s60, 8192
    buffer_load_dwordx4 v5, s[12:15], s60 offen lds
    s_add_u32 m0, m0, 1024
    s_add_u32 s60, s60, 8192
    buffer_load_dwordx4 v5, s[12:15], s60 offen lds
    s_add_u32 m0, s57, 90112
    s_nop 0
    buffer_load_dwordx4 v6, s[8:11], s61 offen lds
    s_add_u32 s68, s67, 3
    s_add_u32 s65, s68, s54
    s_and_b32 s65, s65, 15
    s_lshl_b32 s60, s65, 17
    s_lshl_b32 s61, s65, 7
    s_add_u32 m0, s56, 98304
    s_waitcnt vmcnt(5)
    s_barrier
    buffer_load_dwordx4 v5, s[12:15], s60 offen lds
    s_add_u32 m0, m0, 1024
    s_add_u32 s60, s60, 8192
    buffer_load_dwordx4 v5, s[12:15], s60 offen lds
    s_add_u32 m0, m0, 1024
    s_add_u32 s60, s60, 8192
    buffer_load_dwordx4 v5, s[12:15], s60 offen lds
    s_add_u32 m0, m0, 1024
    s_add_u32 s60, s60, 8192
    buffer_load_dwordx4 v5, s[12:15], s60 offen lds
    s_add_u32 m0, s57, 94208
    s_nop 0
    buffer_load_dwordx4 v6, s[8:11], s61 offen lds
    s_add_u32 s67, s67, 4
    s_cmp_lt_u32 s67, 16
    s_cbranch_scc1 H_P2L
    s_waitcnt vmcnt(5)
    s_barrier
    s_add_u32 s60, s71, 0
    s_and_b32 s60, s60, 7
    s_lshl_b32 s60, s60, 12
    s_add_u32 s60, s60, s66
    buffer_load_dword v117, v118, s[20:23], s60 offen sc1
    s_waitcnt vmcnt(1)
    s_barrier
    s_waitcnt vmcnt(0)
    v_cmp_ne_u32 vcc, s52, v117
    s_cbranch_vccz H_PK0_G
    s_mov_b32 s79, 20000
H_PK0_L:
    s_add_u32 s60, s71, 0
    s_and_b32 s60, s60, 7
    s_lshl_b32 s60, s60, 12
    s_add_u32 s60, s60, s66
    buffer_load_dword v117, v118, s[20:23], s60 offen sc1
    s_waitcnt vmcnt(0)
    v_cmp_ne_u32 vcc, s52, v117
    s_cbranch_vccz H_PK0_G
    s_sub_u32 s79, s79, 1
    s_cmp_eq_u32 s79, 0
    s_cbranch_scc1 H_PK0_G
    s_sleep 4
    s_branch H_PK0_L
H_PK0_G:
    s_add_u32 s60, s71, 1
    s_and_b32 s60, s60, 7
    s_lshl_b32 s60, s60, 12
    s_add_u32 s60, s60, s66
    buffer_load_dword v117, v118, s[20:23], s60 offen sc1
    s_add_u32 s60, s71, 0
    s_and_b32 s60, s60, 7
    s_lshl_b32 s60, s60, 15
    s_add_u32 s60, s60, s58
    s_add_u32 s60, s60, 8388608
    s_add_u32 m0, s58, 131072
    s_nop 0
    buffer_load_dwordx4 v2, s[20:23], s60 offen offset:0 sc1 lds
    buffer_load_dwordx4 v2, s[20:23], s60 offen offset:1024 sc1 lds
    buffer_load_dwordx4 v2, s[20:23], s60 offen offset:2048 sc1 lds
    buffer_load_dwordx4 v2, s[20:23], s60 offen offset:3072 sc1 lds
    s_add_u32 m0, m0, 4096
    s_add_u32 s60, s60, 4096
    buffer_load_dwordx4 v2, s[20:23], s60 offen offset:0 sc1 lds
    buffer_load_dwordx4 v2, s[20:23], s60 offen offset:1024 sc1 lds
    buffer_load_dwordx4 v2, s[20:23], s60 offen offset:2048 sc1 lds
    buffer_load_dwordx4 v2, s[20:23], s60 offen offset:3072 sc1 lds
    s_lshl_b32 s54, s5, 1
    s_xor_b32 s76, s2, 24
    s_or_b32 s76, s76, s55
    s_cmp_lg_u32 s76, 0
    s_cbranch_scc1 H_NOTOP0
    v_lshlrev_b32 v3, 8, v0
    s_mov_b32 s60, 2949120
    buffer_load_dword v12, v3, s[20:23], s60 offen sc1
    buffer_load_dword v13, v3, s[20:23], s60 offen offset:128 sc1
    s_waitcnt vmcnt(2)
    s_barrier
    s_waitcnt vmcnt(0)
    s_branch H_B0
H_NOTOP0:
    s_waitcnt vmcnt(0)
    s_barrier
H_B0:
    v_cmp_ne_u32 vcc, s52, v117
    s_cbranch_vccz H_PK1_G
    s_mov_b32 s79, 20000
H_PK1_L:
    s_add_u32 s60, s71, 1
    s_and_b32 s60, s60, 7
    s_lshl_b32 s60, s60, 12
    s_add_u32 s60, s60, s66
    buffer_load_dword v117, v118, s[20:23], s60 offen sc1
    s_waitcnt vmcnt(0)
    v_cmp_ne_u32 vcc, s52, v117
    s_cbranch_vccz H_PK1_G
    s_sub_u32 s79, s79, 1
    s_cmp_eq_u32 s79, 0
    s_cbranch_scc1 H_PK1_G
    s_sleep 4
    s_branch H_PK1_L
H_PK1_G:
    s_add_u32 s60, s71, 2
    s_and_b32 s60, s60, 7
    s_lshl_b32 s60, s60, 12
    s_add_u32 s60, s60, s66
    buffer_load_dword v117, v118, s[20:23], s60 offen sc1
    s_add_u32 s60, s71, 1
    s_and_b32 s60, s60, 7
    s_lshl_b32 s60, s60, 15
    s_add_u32 s60, s60, s58
    s_add_u32 s60, s60, 8388608
    s_add_u32 m0, s58, 98304
    s_nop 0
    buffer_load_dwordx4 v2, s[20:23], s60 offen offset:0 sc1 lds
    buffer_load_dwordx4 v2, s[20:23], s60 offen offset:1024 sc1 lds
    buffer_load_dwordx4 v2, s[20:23], s60 offen offset:2048 sc1 lds
    buffer_load_dwordx4 v2, s[20:23], s60 offen offset:3072 sc1 lds
    s_add_u32 m0, m0, 4096
    s_add_u32 s60, s60, 4096
    buffer_load_dwordx4 v2, s[20:23], s60 offen offset:0 sc1 lds
    buffer_load_dwordx4 v2, s[20:23], s60 offen offset:1024 sc1 lds
    buffer_load_dwordx4 v2, s[20:23], s60 offen offset:2048 sc1 lds
    buffer_load_dwordx4 v2, s[20:23], s60 offen offset:3072 sc1 lds
    s_cmp_lg_u32 s76, 0
    s_cbranch_scc1 H_NOTOP
    v_xor_b32 v12, s52, v12
    v_xor_b32 v13, s52, v13
    v_or_b32 v12, v12, v13
    v_cmp_ne_u32 vcc, 0, v12
    s_cbranch_vccz H_PR_G
    s_mov_b32 s79, 20000
H_PR_L:
    v_lshlrev_b32 v3, 8, v0
    s_mov_b32 s60, 2949120
    buffer_load_dword v12, v3, s[20:23], s60 offen sc1
    buffer_load_dword v13, v3, s[20:23], s60 offen offset:128 sc1
    s_waitcnt vmcnt(0)
    v_xor_b32 v12, s52, v12
    v_xor_b32 v13, s52, v13
    v_or_b32 v12, v12, v13
    v_cmp_ne_u32 vcc, 0, v12
    s_cbranch_vccz H_PR_G
    s_sub_u32 s79, s79, 1
    s_cmp_eq_u32 s79, 0
    s_cbranch_scc1 H_PR_G
    s_sleep 4
    s_branch H_PR_L
H_PR_G:
    s_mov_b32 m0, 0
    s_mov_b32 s60, 8658944
    buffer_load_dwordx4 v2, s[20:23], s60 offen offset:0 sc1 lds
    buffer_load_dwordx4 v2, s[20:23], s60 offen offset:1024 sc1 lds
    buffer_load_dwordx4 v2, s[20:23], s60 offen offset:2048 sc1 lds
    buffer_load_dwordx4 v2, s[20:23], s60 offen offset:3072 sc1 lds
    s_mov_b32 m0, 4096
    s_mov_b32 s60, 8663040
    buffer_load_dwordx4 v2, s[20:23], s60 offen offset:0 sc1 lds
    buffer_load_dwordx4 v2, s[20:23], s60 offen offset:1024 sc1 lds
    buffer_load_dwordx4 v2, s[20:23], s60 offen offset:2048 sc1 lds
    buffer_load_dwordx4 v2, s[20:23], s60 offen offset:3072 sc1 lds
    v_lshlrev_b32 v3, 2, v0
    s_mov_b32 s60, 8667136
    buffer_load_dword v16, v3, s[20:23], s60 offen sc1
    s_waitcnt vmcnt(0)
    v_lshrrev_b32 v19, 3, v0
    v_mov_b32 v18, 0
    v_mov_b32 v17, v16
    s_nop 1
    v_max_u32_dpp v17, v17, v17 row_shr:1 row_mask:0xf bank_mask:0xf
    s_nop 1
    v_max_u32_dpp v17, v17, v17 row_shr:2 row_mask:0xf bank_mask:0xf
    s_nop 1
    v_max_u32_dpp v17, v17, v17 row_shr:4 row_mask:0xf bank_mask:0xf
    s_nop 1
    v_max_u32_dpp v17, v17, v17 row_shr:8 row_mask:0xf bank_mask:0xf
    s_nop 1
    v_max_u32_dpp v17, v17, v17 row_bcast:15 row_mask:0xa bank_mask:0xf
    s_nop 1
    v_max_u32_dpp v17, v17, v17 row_bcast:31 row_mask:0xc bank_mask:0xf
    s_nop 0
    v_readlane_b32 s60, v17, 63
    s_nop 1
    v_cmp_eq_u32 vcc, s60, v16
    s_nop 1
    v_cndmask_b32 v16, v16, 0, vcc
    v_mov_b32 v20, s60
    v_cmp_eq_u32 vcc, 0, v19
    s_nop 1
    v_cndmask_b32 v18, v18, v20, vcc
    v_mov_b32 v17, v16
    s_nop 1
    v_max_u32_dpp v17, v17, v17 row_shr:1 row_mask:0xf bank_mask:0xf
    s_nop 1
    v_max_u32_dpp v17, v17, v17 row_shr:2 row_mask:0xf bank_mask:0xf
    s_nop 1
    v_max_u32_dpp v17, v17, v17 row_shr:4 row_mask:0xf bank_mask:0xf
    s_nop 1
    v_max_u32_dpp v17, v17, v17 row_shr:8 row_mask:0xf bank_mask:0xf
    s_nop 1
    v_max_u32_dpp v17, v17, v17 row_bcast:15 row_mask:0xa bank_mask:0xf
    s_nop 1
    v_max_u32_dpp v17, v17, v17 row_bcast:31 row_mask:0xc bank_mask:0xf
    s_nop 0
    v_readlane_b32 s60, v17, 63
    s_nop 1
    v_cmp_eq_u32 vcc, s60, v16
    s_nop 1
    v_cndmask_b32 v16, v16, 0, vcc
    v_mov_b32 v20, s60
    v_cmp_eq_u32 vcc, 1, v19
    s_nop 1
    v_cndmask_b32 v18, v18, v20, vcc
    v_mov_b32 v17, v16
    s_nop 1
    v_max_u32_dpp v17, v17, v17 row_shr:1 row_mask:0xf bank_mask:0xf
    s_nop 1
    v_max_u32_dpp v17, v17, v17 row_shr:2 row_mask:0xf bank_mask:0xf
    s_nop 1
    v_max_u32_dpp v17, v17, v17 row_shr:4 row_mask:0xf bank_mask:0xf
    s_nop 1
    v_max_u32_dpp v17, v17, v17 row_shr:8 row_mask:0xf bank_mask:0xf
    s_nop 1
    v_max_u32_dpp v17, v17, v17 row_bcast:15 row_mask:0xa bank_mask:0xf
    s_nop 1
    v_max_u32_dpp v17, v17, v17 row_bcast:31 row_mask:0xc bank_mask:0xf
    s_nop 0
    v_readlane_b32 s60, v17, 63
    s_nop 1
    v_cmp_eq_u32 vcc, s60, v16
    s_nop 1
    v_cndmask_b32 v16, v16, 0, vcc
    v_mov_b32 v20, s60
    v_cmp_eq_u32 vcc, 2, v19
    s_nop 1
    v_cndmask_b32 v18, v18, v20, vcc
    v_mov_b32 v17, v16
    s_nop 1
    v_max_u32_dpp v17, v17, v17 row_shr:1 row_mask:0xf bank_mask:0xf
    s_nop 1
    v_max_u32_dpp v17, v17, v17 row_shr:2 row_mask:0xf bank_mask:0xf
    s_nop 1
    v_max_u32_dpp v17, v17, v17 row_shr:4 row_mask:0xf bank_mask:0xf
    s_nop 1
    v_max_u32_dpp v17, v17, v17 row_shr:8 row_mask:0xf bank_mask:0xf
    s_nop 1
    v_max_u32_dpp v17, v17, v17 row_bcast:15 row_mask:0xa bank_mask:0xf
    s_nop 1
    v_max_u32_dpp v17, v17, v17 row_bcast:31 row_mask:0xc bank_mask:0xf
    s_nop 0
    v_readlane_b32 s60, v17, 63
    s_nop 1
    v_cmp_eq_u32 vcc, s60, v16
    s_nop 1
    v_cndmask_b32 v16, v16, 0, vcc
    v_mov_b32 v20, s60
    v_cmp_eq_u32 vcc, 3, v19
    s_nop 1
    v_cndmask_b32 v18, v18, v20, vcc
    v_mov_b32 v17, v16
    s_nop 1
    v_max_u32_dpp v17, v17, v17 row_shr:1 row_mask:0xf bank_mask:0xf
    s_nop 1
    v_max_u32_dpp v17, v17, v17 row_shr:2 row_mask:0xf bank_mask:0xf
    s_nop 1
    v_max_u32_dpp v17, v17, v17 row_shr:4 row_mask:0xf bank_mask:0xf
    s_nop 1
    v_max_u32_dpp v17, v17, v17 row_shr:8 row_mask:0xf bank_mask:0xf
    s_nop 1
    v_max_u32_dpp v17, v17, v17 row_bcast:15 row_mask:0xa bank_mask:0xf
    s_nop 1
    v_max_u32_dpp v17, v17, v17 row_bcast:31 row_mask:0xc bank_mask:0xf
    s_nop 0
    v_readlane_b32 s60, v17, 63
    s_nop 1
    v_cmp_eq_u32 vcc, s60, v16
    s_nop 1
    v_cndmask_b32 v16, v16, 0, vcc
    v_mov_b32 v20, s60
    v_cmp_eq_u32 vcc, 4, v19
    s_nop 1
    v_cndmask_b32 v18, v18, v20, vcc
    v_mov_b32 v17, v16
    s_nop 1
    v_max_u32_dpp v17, v17, v17 row_shr:1 row_mask:0xf bank_mask:0xf
    s_nop 1
    v_max_u32_dpp v17, v17, v17 row_shr:2 row_mask:0xf bank_mask:0xf
    s_nop 1
    v_max_u32_dpp v17, v17, v17 row_shr:4 row_mask:0xf bank_mask:0xf
    s_nop 1
    v_max_u32_dpp v17, v17, v17 row_shr:8 row_mask:0xf bank_mask:0xf
    s_nop 1
    v_max_u32_dpp v17, v17, v17 row_bcast:15 row_mask:0xa bank_mask:0xf
    s_nop 1
    v_max_u32_dpp v17, v17, v17 row_bcast:31 row_mask:0xc bank_mask:0xf
    s_nop 0
    v_readlane_b32 s60, v17, 63
    s_nop 1
    v_cmp_eq_u32 vcc, s60, v16
    s_nop 1
    v_cndmask_b32 v16, v16, 0, vcc
    v_mov_b32 v20, s60
    v_cmp_eq_u32 vcc, 5, v19
    s_nop 1
    v_cndmask_b32 v18, v18, v20, vcc
    v_mov_b32 v17, v16
    s_nop 1
    v_max_u32_dpp v17, v17, v17 row_shr:1 row_mask:0xf bank_mask:0xf
    s_nop 1
    v_max_u32_dpp v17, v17, v17 row_shr:2 row_mask:0xf bank_mask:0xf
    s_nop 1
    v_max_u32_dpp v17, v17, v17 row_shr:4 row_mask:0xf bank_mask:0xf
    s_nop 1
    v_max_u32_dpp v17, v17, v17 row_shr:8 row_mask:0xf bank_mask:0xf
    s_nop 1
    v_max_u32_dpp v17, v17, v17 row_bcast:15 row_mask:0xa bank_mask:0xf
    s_nop 1
    v_max_u32_dpp v17, v17, v17 row_bcast:31 row_mask:0xc bank_mask:0xf
    s_nop 0
    v_readlane_b32 s60, v17, 63
    s_nop 1
    v_cmp_eq_u32 vcc, s60, v16
    s_nop 1
    v_cndmask_b32 v16, v16, 0, vcc
    v_mov_b32 v20, s60
    v_cmp_eq_u32 vcc, 6, v19
    s_nop 1
    v_cndmask_b32 v18, v18, v20, vcc
    v_mov_b32 v17, v16
    s_nop 1
    v_max_u32_dpp v17, v17, v17 row_shr:1 row_mask:0xf bank_mask:0xf
    s_nop 1
    v_max_u32_dpp v17, v17, v17 row_shr:2 row_mask:0xf bank_mask:0xf
    s_nop 1
    v_max_u32_dpp v17, v17, v17 row_shr:4 row_mask:0xf bank_mask:0xf
    s_nop 1
    v_max_u32_dpp v17, v17, v17 row_shr:8 row_mask:0xf bank_mask:0xf
    s_nop 1
    v_max_u32_dpp v17, v17, v17 row_bcast:15 row_mask:0xa bank_mask:0xf
    s_nop 1
    v_max_u32_dpp v17, v17, v17 row_bcast:31 row_mask:0xc bank_mask:0xf
    s_nop 0
    v_readlane_b32 s60, v17, 63
    s_nop 1
    v_cmp_eq_u32 vcc, s60, v16
    s_nop 1
    v_cndmask_b32 v16, v16, 0, vcc
    v_mov_b32 v20, s60
    v_cmp_eq_u32 vcc, 7, v19
    s_nop 1
    v_cndmask_b32 v18, v18, v20, vcc
    v_and_b32 v18, 0xffff, v18
    v_sub_u32 v18, 0xffff, v18
    v_bfe_u32 v18, v18, 5, 6
    v_and_b32 v20, 7, v0
    v_lshlrev_b32 v20, 4, v20
    v_lshl_add_u32 v18, v18, 7, v20
    v_add_u32 v18, 0, v18
    ds_read_b128 v[24:27], v18
    s_waitcnt lgkmcnt(0)
H_NOTOP:
    s_cmp_eq_u32 s64, 0
    s_cbranch_scc1 H_NF1
    s_add_u32 m0, s58, 0
    s_mov_b32 s60, 0
    buffer_load_dwordx4 v7, s[32:35], s60 offen nt lds
    s_add_u32 m0, m0, 1024
    s_add_u32 s60, s60, 57344
    buffer_load_dwordx4 v112, s[32:35], s60 offen nt lds
    s_add_u32 m0, m0, 1024
    s_add_u32 s60, s60, 57344
    buffer_load_dwordx4 v7, s[32:35], s60 offen nt lds
    s_add_u32 m0, m0, 1024
    s_add_u32 s60, s60, 57344
    buffer_load_dwordx4 v112, s[32:35], s60 offen nt lds
    s_waitcnt vmcnt(4)
    s_branch H_NJ1
H_NF1:
    s_waitcnt vmcnt(0) lgkmcnt(0)
H_NJ1:
    s_barrier
    v_cmp_ne_u32 vcc, s52, v117
    s_cbranch_vccz H_PK2_G
    s_mov_b32 s79, 20000
H_PK2_L:
    s_add_u32 s60, s71, 2
    s_and_b32 s60, s60, 7
    s_lshl_b32 s60, s60, 12
    s_add_u32 s60, s60, s66
    buffer_load_dword v117, v118, s[20:23], s60 offen sc1
    s_waitcnt vmcnt(0)
    v_cmp_ne_u32 vcc, s52, v117
    s_cbranch_vccz H_PK2_G
    s_sub_u32 s79, s79, 1
    s_cmp_eq_u32 s79, 0
    s_cbranch_scc1 H_PK2_G
    s_sleep 4
    s_branch H_PK2_L
H_PK2_G:
    s_add_u32 s60, s71, 3
    s_and_b32 s60, s60, 7
    s_lshl_b32 s60, s60, 12
    s_add_u32 s60, s60, s66
    buffer_load_dword v117, v118, s[20:23], s60 offen sc1
    s_add_u32 s60, s71, 2
    s_and_b32 s60, s60, 7
    s_lshl_b32 s60, s60, 15
    s_add_u32 s60, s60, s58
    s_add_u32 s60, s60, 8388608
    s_add_u32 m0, s58, 131072
    s_nop 0
    buffer_load_dwordx4 v2, s[20:23], s60 offen offset:0 sc1 lds
    buffer_load_dwordx4 v2, s[20:23], s60 offen offset:1024 sc1 lds
    buffer_load_dwordx4 v2, s[20:23], s60 offen offset:2048 sc1 lds
    buffer_load_dwordx4 v2, s[20:23], s60 offen offset:3072 sc1 lds
    s_add_u32 m0, m0, 4096
    s_add_u32 s60, s60, 4096
    buffer_load_dwordx4 v2, s[20:23], s60 offen offset:0 sc1 lds
    buffer_load_dwordx4 v2, s[20:23], s60 offen offset:1024 sc1 lds
    buffer_load_dwordx4 v2, s[20:23], s60 offen offset:2048 sc1 lds
    buffer_load_dwordx4 v2, s[20:23], s60 offen offset:3072 sc1 lds
    s_cmp_lg_u32 s76, 0
    s_cbranch_scc1 H_NOTOP2
    v_max_u32 v21, v24, v25
    v_min_u32 v25, v24, v25
    v_mov_b32 v24, v21
    v_max_u32 v21, v26, v27
    v_min_u32 v27, v26, v27
    v_mov_b32 v26, v21
    v_max_u32 v21, v24, v26
    v_min_u32 v26, v24, v26
    v_mov_b32 v24, v21
    v_max_u32 v21, v25, v27
    v_min_u32 v27, v25, v27
    v_mov_b32 v25, v21
    v_max_u32 v21, v25, v26
    v_min_u32 v26, v25, v26
    v_mov_b32 v25, v21
    v_mov_b32 v18, 0
    v_mov_b32 v17, v24
    s_nop 1
    v_max_u32_dpp v17, v17, v17 row_shr:1 row_mask:0xf bank_mask:0xf
    s_nop 1
    v_max_u32_dpp v17, v17, v17 row_shr:2 row_mask:0xf bank_mask:0xf
    s_nop 1
    v_max_u32_dpp v17, v17, v17 row_shr:4 row_mask:0xf bank_mask:0xf
    s_nop 1
    v_max_u32_dpp v17, v17, v17 row_shr:8 row_mask:0xf bank_mask:0xf
    s_nop 1
    v_max_u32_dpp v17, v17, v17 row_bcast:15 row_mask:0xa bank_mask:0xf
    s_nop 1
    v_max_u32_dpp v17, v17, v17 row_bcast:31 row_mask:0xc bank_mask:0xf
    s_nop 0
    v_readlane_b32 s60, v17, 63
    s_nop 1
    v_cmp_eq_u32 vcc, s60, v24
    s_nop 1
    v_cndmask_b32 v24, v24, v25, vcc
    v_cndmask_b32 v25, v25, v26, vcc
    v_cndmask_b32 v26, v26, v27, vcc
    v_cndmask_b32 v27, v27, 0, vcc
    v_writelane_b32 v18, s60, 0
    v_mov_b32 v17, v24
    s_nop 1
    v_max_u32_dpp v17, v17, v17 row_shr:1 row_mask:0xf bank_mask:0xf
    s_nop 1
    v_max_u32_dpp v17, v17, v17 row_shr:2 row_mask:0xf bank_mask:0xf
    s_nop 1
    v_max_u32_dpp v17, v17, v17 row_shr:4 row_mask:0xf bank_mask:0xf
    s_nop 1
    v_max_u32_dpp v17, v17, v17 row_shr:8 row_mask:0xf bank_mask:0xf
    s_nop 1
    v_max_u32_dpp v17, v17, v17 row_bcast:15 row_mask:0xa bank_mask:0xf
    s_nop 1
    v_max_u32_dpp v17, v17, v17 row_bcast:31 row_mask:0xc bank_mask:0xf
    s_nop 0
    v_readlane_b32 s60, v17, 63
    s_nop 1
    v_cmp_eq_u32 vcc, s60, v24
    s_nop 1
    v_cndmask_b32 v24, v24, v25, vcc
    v_cndmask_b32 v25, v25, v26, vcc
    v_cndmask_b32 v26, v26, v27, vcc
    v_cndmask_b32 v27, v27, 0, vcc
    v_writelane_b32 v18, s60, 1
    v_mov_b32 v17, v24
    s_nop 1
    v_max_u32_dpp v17, v17, v17 row_shr:1 row_mask:0xf bank_mask:0xf
    s_nop 1
    v_max_u32_dpp v17, v17, v17 row_shr:2 row_mask:0xf bank_mask:0xf
    s_nop 1
    v_max_u32_dpp v17, v17, v17 row_shr:4 row_mask:0xf bank_mask:0xf
    s_nop 1
    v_max_u32_dpp v17, v17, v17 row_shr:8 row_mask:0xf bank_mask:0xf
    s_nop 1
    v_max_u32_dpp v17, v17, v17 row_bcast:15 row_mask:0xa bank_mask:0xf
    s_nop 1
    v_max_u32_dpp v17, v17, v17 row_bcast:31 row_mask:0xc bank_mask:0xf
    s_nop 0
    v_readlane_b32 s60, v17, 63
    s_nop 1
    v_cmp_eq_u32 vcc, s60, v24
    s_nop 1
    v_cndmask_b32 v24, v24, v25, vcc
    v_cndmask_b32 v25, v25, v26, vcc
    v_cndmask_b32 v26, v26, v27, vcc
    v_cndmask_b32 v27, v27, 0, vcc
    v_writelane_b32 v18, s60, 2
    v_mov_b32 v17, v24
    s_nop 1
    v_max_u32_dpp v17, v17, v17 row_shr:1 row_mask:0xf bank_mask:0xf
    s_nop 1
    v_max_u32_dpp v17, v17, v17 row_shr:2 row_mask:0xf bank_mask:0xf
    s_nop 1
    v_max_u32_dpp v17, v17, v17 row_shr:4 row_mask:0xf bank_mask:0xf
    s_nop 1
    v_max_u32_dpp v17, v17, v17 row_shr:8 row_mask:0xf bank_mask:0xf
    s_nop 1
    v_max_u32_dpp v17, v17, v17 row_bcast:15 row_mask:0xa bank_mask:0xf
    s_nop 1
    v_max_u32_dpp v17, v17, v17 row_bcast:31 row_mask:0xc bank_mask:0xf
    s_nop 0
    v_readlane_b32 s60, v17, 63
    s_nop 1
    v_cmp_eq_u32 vcc, s60, v24
    s_nop 1
    v_cndmask_b32 v24, v24, v25, vcc
    v_cndmask_b32 v25, v25, v26, vcc
    v_cndmask_b32 v26, v26, v27, vcc
    v_cndmask_b32 v27, v27, 0, vcc
    v_writelane_b32 v18, s60, 3
    v_mov_b32 v17, v24
    s_nop 1
    v_max_u32_dpp v17, v17, v17 row_shr:1 row_mask:0xf bank_mask:0xf
    s_nop 1
    v_max_u32_dpp v17, v17, v17 row_shr:2 row_mask:0xf bank_mask:0xf
    s_nop 1
    v_max_u32_dpp v17, v17, v17 row_shr:4 row_mask:0xf bank_mask:0xf
    s_nop 1
    v_max_u32_dpp v17, v17, v17 row_shr:8 row_mask:0xf bank_mask:0xf
    s_nop 1
    v_max_u32_dpp v17, v17, v17 row_bcast:15 row_mask:0xa bank_mask:0xf
    s_nop 1
    v_max_u32_dpp v17, v17, v17 row_bcast:31 row_mask:0xc bank_mask:0xf
    s_nop 0
    v_readlane_b32 s60, v17, 63
    s_nop 1
    v_cmp_eq_u32 vcc, s60, v24
    s_nop 1
    v_cndmask_b32 v24, v24, v25, vcc
    v_cndmask_b32 v25, v25, v26, vcc
    v_cndmask_b32 v26, v26, v27, vcc
    v_cndmask_b32 v27, v27, 0, vcc
    v_writelane_b32 v18, s60, 4
    v_mov_b32 v17, v24
    s_nop 1
    v_max_u32_dpp v17, v17, v17 row_shr:1 row_mask:0xf bank_mask:0xf
    s_nop 1
    v_max_u32_dpp v17, v17, v17 row_shr:2 row_mask:0xf bank_mask:0xf
    s_nop 1
    v_max_u32_dpp v17, v17, v17 row_shr:4 row_mask:0xf bank_mask:0xf
    s_nop 1
    v_max_u32_dpp v17, v17, v17 row_shr:8 row_mask:0xf bank_mask:0xf
    s_nop 1
    v_max_u32_dpp v17, v17, v17 row_bcast:15 row_mask:0xa bank_mask:0xf
    s_nop 1
    v_max_u32_dpp v17, v17, v17 row_bcast:31 row_mask:0xc bank_mask:0xf
    s_nop 0
    v_readlane_b32 s60, v17, 63
    s_nop 1
    v_cmp_eq_u32 vcc, s60, v24
    s_nop 1
    v_cndmask_b32 v24, v24, v25, vcc
    v_cndmask_b32 v25, v25, v26, vcc
    v_cndmask_b32 v26, v26, v27, vcc
    v_cndmask_b32 v27, v27, 0, vcc
    v_writelane_b32 v18, s60, 5
    v_mov_b32 v17, v24
    s_nop 1
    v_max_u32_dpp v17, v17, v17 row_shr:1 row_mask:0xf bank_mask:0xf
    s_nop 1
    v_max_u32_dpp v17, v17, v17 row_shr:2 row_mask:0xf bank_mask:0xf
    s_nop 1
    v_max_u32_dpp v17, v17, v17 row_shr:4 row_mask:0xf bank_mask:0xf
    s_nop 1
    v_max_u32_dpp v17, v17, v17 row_shr:8 row_mask:0xf bank_mask:0xf
    s_nop 1
    v_max_u32_dpp v17, v17, v17 row_bcast:15 row_mask:0xa bank_mask:0xf
    s_nop 1
    v_max_u32_dpp v17, v17, v17 row_bcast:31 row_mask:0xc bank_mask:0xf
    s_nop 0
    v_readlane_b32 s60, v17, 63
    s_nop 1
    v_cmp_eq_u32 vcc, s60, v24
    s_nop 1
    v_cndmask_b32 v24, v24, v25, vcc
    v_cndmask_b32 v25, v25, v26, vcc
    v_cndmask_b32 v26, v26, v27, vcc
    v_cndmask_b32 v27, v27, 0, vcc
    v_writelane_b32 v18, s60, 6
    v_mov_b32 v17, v24
    s_nop 1
    v_max_u32_dpp v17, v17, v17 row_shr:1 row_mask:0xf bank_mask:0xf
    s_nop 1
    v_max_u32_dpp v17, v17, v17 row_shr:2 row_mask:0xf bank_mask:0xf
    s_nop 1
    v_max_u32_dpp v17, v17, v17 row_shr:4 row_mask:0xf bank_mask:0xf
    s_nop 1
    v_max_u32_dpp v17, v17, v17 row_shr:8 row_mask:0xf bank_mask:0xf
    s_nop 1
    v_max_u32_dpp v17, v17, v17 row_bcast:15 row_mask:0xa bank_mask:0xf
    s_nop 1
    v_max_u32_dpp v17, v17, v17 row_bcast:31 row_mask:0xc bank_mask:0xf
    s_nop 0
    v_readlane_b32 s60, v17, 63
    s_nop 1
    v_cmp_eq_u32 vcc, s60, v24
    s_nop 1
    v_cndmask_b32 v24, v24, v25, vcc
    v_cndmask_b32 v25, v25, v26, vcc
    v_cndmask_b32 v26, v26, v27, vcc
    v_cndmask_b32 v27, v27, 0, vcc
    v_writelane_b32 v18, s60, 7
    v_lshlrev_b32 v20, 3, v0
    v_mov_b32 v19, s52
    v_mov_b32 v21, 0x40000000
    v_cmp_gt_u32 vcc, 8, v0
    s_nop 1
    v_cndmask_b32 v20, v21, v20, vcc
    s_mov_b32 s60, 8671232
    buffer_store_dwordx2 v[18:19], v20, s[20:23], s60 offen sc1
    s_waitcnt vmcnt(1)
    s_barrier
    s_branch H_B2
H_NOTOP2:
    s_cmp_eq_u32 s64, 0
    s_cbranch_scc1 H_NF2
    s_add_u32 m0, s58, 4096
    s_mov_b32 s60, 229376
    buffer_load_dwordx4 v7, s[32:35], s60 offen nt lds
    s_add_u32 m0, m0, 1024
    s_add_u32 s60, s60, 57344
    buffer_load_dwordx4 v112, s[32:35], s60 offen nt lds
    s_add_u32 m0, m0, 1024
    s_add_u32 s60, s60, 57344
    buffer_load_dwordx4 v7, s[32:35], s60 offen nt lds
    s_add_u32 m0, m0, 1024
    s_add_u32 s60, s60, 57344
    buffer_load_dwordx4 v112, s[32:35], s60 offen nt lds
    s_waitcnt vmcnt(4)
    s_branch H_NJ2
H_NF2:
    s_waitcnt vmcnt(0) lgkmcnt(0)
H_NJ2:
    s_barrier
H_B2:
    v_cmp_ne_u32 vcc, s52, v117
    s_cbranch_vccz H_PK3_G
    s_mov_b32 s79, 20000
H_PK3_L:
    s_add_u32 s60, s71, 3
    s_and_b32 s60, s60, 7
    s_lshl_b32 s60, s60, 12
    s_add_u32 s60, s60, s66
    buffer_load_dword v117, v118, s[20:23], s60 offen sc1
    s_waitcnt vmcnt(0)
    v_cmp_ne_u32 vcc, s52, v117
    s_cbranch_vccz H_PK3_G
    s_sub_u32 s79, s79, 1
    s_cmp_eq_u32 s79, 0
    s_cbranch_scc1 H_PK3_G
    s_sleep 4
    s_branch H_PK3_L
H_PK3_G:
    s_add_u32 s60, s71, 4
    s_and_b32 s60, s60, 7
    s_lshl_b32 s60, s60, 12
    s_add_u32 s60, s60, s66
    buffer_load_dword v117, v118, s[20:23], s60 offen sc1
    s_add_u32 s60, s71, 3
    s_and_b32 s60, s60, 7
    s_lshl_b32 s60, s60, 15
    s_add_u32 s60, s60, s58
    s_add_u32 s60, s60, 8388608
    s_add_u32 m0, s58, 98304
    s_nop 0
    buffer_load_dwordx4 v2, s[20:23], s60 offen offset:0 sc1 lds
    buffer_load_dwordx4 v2, s[20:23], s60 offen offset:1024 sc1 lds
    buffer_load_dwordx4 v2, s[20:23], s60 offen offset:2048 sc1 lds
    buffer_load_dwordx4 v2, s[20:23], s60 offen offset:3072 sc1 lds
    s_add_u32 m0, m0, 4096
    s_add_u32 s60, s60, 4096
    buffer_load_dwordx4 v2, s[20:23], s60 offen offset:0 sc1 lds
    buffer_load_dwordx4 v2, s[20:23], s60 offen offset:1024 sc1 lds
    buffer_load_dwordx4 v2, s[20:23], s60 offen offset:2048 sc1 lds
    buffer_load_dwordx4 v2, s[20:23], s60 offen offset:3072 sc1 lds
    s_cmp_eq_u32 s64, 0
    s_cbranch_scc1 H_NF3
    s_add_u32 m0, s58, 32768
    s_mov_b32 s60, 0
    buffer_load_dwordx4 v7, s[36:39], s60 offen nt lds
    s_add_u32 m0, m0, 1024
    s_add_u32 s60, s60, 57344
    buffer_load_dwordx4 v112, s[36:39], s60 offen nt lds
    s_add_u32 m0, m0, 1024
    s_add_u32 s60, s60, 57344
    buffer_load_dwordx4 v7, s[36:39], s60 offen nt lds
    s_add_u32 m0, m0, 1024
    s_add_u32 s60, s60, 57344
    buffer_load_dwordx4 v112, s[36:39], s60 offen nt lds
    s_add_u32 m0, m0, 1024
    s_add_u32 s60, s60, 57344
    buffer_load_dwordx4 v7, s[36:39], s60 offen nt lds
    s_add_u32 m0, m0, 1024
    s_add_u32 s60, s60, 57344
    buffer_load_dwordx4 v112, s[36:39], s60 offen nt lds
    s_add_u32 m0, m0, 1024
    s_add_u32 s60, s60, 57344
    buffer_load_dwordx4 v7, s[36:39], s60 offen nt lds
    s_add_u32 m0, m0, 1024
    s_add_u32 s60, s60, 57344
    buffer_load_dwordx4 v112, s[36:39], s60 offen nt lds
    s_waitcnt vmcnt(8)
    s_branch H_NJ3
H_NF3:
    s_waitcnt vmcnt(0) lgkmcnt(0)
H_NJ3:
    s_barrier
    s_mov_b32 s60, 8671232
    buffer_load_dwordx2 v[8:9], v97, s[20:23], s60 offen sc1
    v_cmp_ne_u32 vcc, s52, v117
    s_cbranch_vccz H_PK4_G
    s_mov_b32 s79, 20000
H_PK4_L:
    s_add_u32 s60, s71, 4
    s_and_b32 s60, s60, 7
    s_lshl_b32 s60, s60, 12
    s_add_u32 s60, s60, s66
    buffer_load_dword v117, v118, s[20:23], s60 offen sc1
    s_waitcnt vmcnt(0)
    v_cmp_ne_u32 vcc, s52, v117
    s_cbranch_vccz H_PK4_G
    s_sub_u32 s79, s79, 1
    s_cmp_eq_u32 s79, 0
    s_cbranch_scc1 H_PK4_G
    s_sleep 4
    s_branch H_PK4_L
H_PK4_G:
    s_add_u32 s60, s71, 5
    s_and_b32 s60, s60, 7
    s_lshl_b32 s60, s60, 12
    s_add_u32 s60, s60, s66
    buffer_load_dword v117, v118, s[20:23], s60 offen sc1
    s_add_u32 s60, s71, 4
    s_and_b32 s60, s60, 7
    s_lshl_b32 s60, s60, 15
    s_add_u32 s60, s60, s58
    s_add_u32 s60, s60, 8388608
    s_add_u32 m0, s58, 131072
    s_nop 0
    buffer_load_dwordx4 v2, s[20:23], s60 offen offset:0 sc1 lds
    buffer_load_dwordx4 v2, s[20:23], s60 offen offset:1024 sc1 lds
    buffer_load_dwordx4 v2, s[20:23], s60 offen offset:2048 sc1 lds
    buffer_load_dwordx4 v2, s[20:23], s60 offen offset:3072 sc1 lds
    s_add_u32 m0, m0, 4096
    s_add_u32 s60, s60, 4096
    buffer_load_dwordx4 v2, s[20:23], s60 offen offset:0 sc1 lds
    buffer_load_dwordx4 v2, s[20:23], s60 offen offset:1024 sc1 lds
    buffer_load_dwordx4 v2, s[20:23], s60 offen offset:2048 sc1 lds
    buffer_load_dwordx4 v2, s[20:23], s60 offen offset:3072 sc1 lds
    s_waitcnt vmcnt(8)
    v_cmp_ne_u32 vcc, s52, v9
    s_cbranch_vccz H_I2
    s_mov_b32 s79, 20000
H_PI_L:
    s_mov_b32 s60, 8671232
    buffer_load_dwordx2 v[8:9], v97, s[20:23], s60 offen sc1
    s_waitcnt vmcnt(0)
    v_cmp_ne_u32 vcc, s52, v9
    s_cbranch_vccz H_PI_G
    s_sub_u32 s79, s79, 1
    s_cmp_eq_u32 s79, 0
    s_cbranch_scc1 H_PI_G
    s_sleep 4
    s_branch H_PI_L
H_PI_G:
H_I2:
    v_not_b32 v10, v8
    v_and_b32 v10, 2047, v10
    s_cmp_eq_u32 s64, 0
    s_cbranch_scc1 H_NF4
    v_lshl_add_u32 v3, v10, 11, v98
    s_and_b32 s60, s59, 3
    s_lshl_b32 s60, s60, 9
    buffer_load_dwordx4 v[16:19], v3, s[8:11], s60 offen offset:0
    buffer_load_dwordx4 v[20:23], v3, s[8:11], s60 offen offset:64
    buffer_load_dwordx4 v[24:27], v3, s[8:11], s60 offen offset:128
    buffer_load_dwordx4 v[28:31], v3, s[8:11], s60 offen offset:192
    buffer_load_dwordx4 v[32:35], v3, s[8:11], s60 offen offset:256
    buffer_load_dwordx4 v[36:39], v3, s[8:11], s60 offen offset:320
    buffer_load_dwordx4 v[40:43], v3, s[8:11], s60 offen offset:384
    buffer_load_dwordx4 v[44:47], v3, s[8:11], s60 offen offset:448
    s_mov_b32 s60, 0
    s_add_u32 m0, s58, 65536
    s_nop 0
    buffer_load_dwordx4 v96, s[40:43], s60 offen nt lds
    s_add_u32 m0, m0, 1024
    s_add_u32 s60, s60, 8192
    buffer_load_dwordx4 v96, s[40:43], s60 offen nt lds
    s_add_u32 m0, m0, 1024
    s_add_u32 s60, s60, 8192
    buffer_load_dwordx4 v96, s[40:43], s60 offen nt lds
    s_add_u32 m0, m0, 1024
    s_add_u32 s60, s60, 8192
    buffer_load_dwordx4 v96, s[40:43], s60 offen nt lds
    s_add_u32 m0, m0, 1024
    s_add_u32 s60, s60, 8192
    buffer_load_dwordx4 v96, s[40:43], s60 offen nt lds
    s_add_u32 m0, m0, 1024
    s_add_u32 s60, s60, 8192
    buffer_load_dwordx4 v96, s[40:43], s60 offen nt lds
    s_add_u32 m0, m0, 1024
    s_add_u32 s60, s60, 8192
    buffer_load_dwordx4 v96, s[40:43], s60 offen nt lds
    s_add_u32 m0, m0, 1024
    s_add_u32 s60, s60, 8192
    buffer_load_dwordx4 v96, s[40:43], s60 offen nt lds
    s_waitcnt vmcnt(8)
    s_branch H_NJ4
H_NF4:
    s_waitcnt vmcnt(0) lgkmcnt(0)
H_NJ4:
    s_barrier
    v_cmp_ne_u32 vcc, s52, v117
    s_cbranch_vccz H_PK5_G
    s_mov_b32 s79, 20000
H_PK5_L:
    s_add_u32 s60, s71, 5
    s_and_b32 s60, s60, 7
    s_lshl_b32 s60, s60, 12
    s_add_u32 s60, s60, s66
    buffer_load_dword v117, v118, s[20:23], s60 offen sc1
    s_waitcnt vmcnt(0)
    v_cmp_ne_u32 vcc, s52, v117
    s_cbranch_vccz H_PK5_G
    s_sub_u32 s79, s79, 1
    s_cmp_eq_u32 s79, 0
    s_cbranch_scc1 H_PK5_G
    s_sleep 4
    s_branch H_PK5_L
H_PK5_G:
    s_add_u32 s60, s71, 6
    s_and_b32 s60, s60, 7
    s_lshl_b32 s60, s60, 12
    s_add_u32 s60, s60, s66
    buffer_load_dword v117, v118, s[20:23], s60 offen sc1
    s_add_u32 s60, s71, 5
    s_and_b32 s60, s60, 7
    s_lshl_b32 s60, s60, 15
    s_add_u32 s60, s60, s58
    s_add_u32 s60, s60, 8388608
    s_add_u32 m0, s58, 98304
    s_nop 0
    buffer_load_dwordx4 v2, s[20:23], s60 offen offset:0 sc1 lds
    buffer_load_dwordx4 v2, s[20:23], s60 offen offset:1024 sc1 lds
    buffer_load_dwordx4 v2, s[20:23], s60 offen offset:2048 sc1 lds
    buffer_load_dwordx4 v2, s[20:23], s60 offen offset:3072 sc1 lds
    s_add_u32 m0, m0, 4096
    s_add_u32 s60, s60, 4096
    buffer_load_dwordx4 v2, s[20:23], s60 offen offset:0 sc1 lds
    buffer_load_dwordx4 v2, s[20:23], s60 offen offset:1024 sc1 lds
    buffer_load_dwordx4 v2, s[20:23], s60 offen offset:2048 sc1 lds
    buffer_load_dwordx4 v2, s[20:23], s60 offen offset:3072 sc1 lds
    s_cmp_eq_u32 s64, 0
    s_cbranch_scc1 H_NF5
    ds_read_b64_tr_b16 v[48:49], v99 offset:0
    ds_read_b64_tr_b16 v[50:51], v99 offset:512
    ds_read_b64_tr_b16 v[52:53], v99 offset:4096
    ds_read_b64_tr_b16 v[54:55], v99 offset:4608
    s_waitcnt lgkmcnt(0)
    v_mfma_f32_16x16x32_bf16 v[80:83], v[48:51], v[16:19], 0
    v_mfma_f32_16x16x32_bf16 v[80:83], v[52:55], v[20:23], v[80:83]
    ds_read_b64_tr_b16 v[56:57], v99 offset:8192
    ds_read_b64_tr_b16 v[58:59], v99 offset:8704
    ds_read_b64_tr_b16 v[60:61], v99 offset:12288
    ds_read_b64_tr_b16 v[62:63], v99 offset:12800
    s_waitcnt lgkmcnt(0)
    v_mfma_f32_16x16x32_bf16 v[80:83], v[56:59], v[24:27], v[80:83]
    v_mfma_f32_16x16x32_bf16 v[80:83], v[60:63], v[28:31], v[80:83]
    ds_read_b64_tr_b16 v[64:65], v99 offset:16384
    ds_read_b64_tr_b16 v[66:67], v99 offset:16896
    ds_read_b64_tr_b16 v[68:69], v99 offset:20480
    ds_read_b64_tr_b16 v[70:71], v99 offset:20992
    s_waitcnt lgkmcnt(0)
    v_mfma_f32_16x16x32_bf16 v[80:83], v[64:67], v[32:35], v[80:83]
    v_mfma_f32_16x16x32_bf16 v[80:83], v[68:71], v[36:39], v[80:83]
    ds_read_b64_tr_b16 v[72:73], v99 offset:24576
    ds_read_b64_tr_b16 v[74:75], v99 offset:25088
    ds_read_b64_tr_b16 v[76:77], v99 offset:28672
    ds_read_b64_tr_b16 v[78:79], v99 offset:29184
    s_waitcnt lgkmcnt(0)
    v_mfma_f32_16x16x32_bf16 v[80:83], v[72:75], v[40:43], v[80:83]
    v_mfma_f32_16x16x32_bf16 v[80:83], v[76:79], v[44:47], v[80:83]
    ds_read_b64_tr_b16 v[48:49], v99 offset:32768
    ds_read_b64_tr_b16 v[50:51], v99 offset:33280
    ds_read_b64_tr_b16 v[52:53], v99 offset:36864
    ds_read_b64_tr_b16 v[54:55], v99 offset:37376
    s_waitcnt lgkmcnt(0)
    v_mfma_f32_16x16x32_bf16 v[84:87], v[48:51], v[16:19], 0
    v_mfma_f32_16x16x32_bf16 v[84:87], v[52:55], v[20:23], v[84:87]
    ds_read_b64_tr_b16 v[56:57], v99 offset:40960
    ds_read_b64_tr_b16 v[58:59], v99 offset:41472
    ds_read_b64_tr_b16 v[60:61], v99 offset:45056
    ds_read_b64_tr_b16 v[62:63], v99 offset:45568
    s_waitcnt lgkmcnt(0)
    v_mfma_f32_16x16x32_bf16 v[84:87], v[56:59], v[24:27], v[84:87]
    v_mfma_f32_16x16x32_bf16 v[84:87], v[60:63], v[28:31], v[84:87]
    ds_read_b64_tr_b16 v[64:65], v99 offset:49152
    ds_read_b64_tr_b16 v[66:67], v99 offset:49664
    ds_read_b64_tr_b16 v[68:69], v99 offset:53248
    ds_read_b64_tr_b16 v[70:71], v99 offset:53760
    s_waitcnt lgkmcnt(0)
    v_mfma_f32_16x16x32_bf16 v[84:87], v[64:67], v[32:35], v[84:87]
    v_mfma_f32_16x16x32_bf16 v[84:87], v[68:71], v[36:39], v[84:87]
    ds_read_b64_tr_b16 v[72:73], v99 offset:57344
    ds_read_b64_tr_b16 v[74:75], v99 offset:57856
    ds_read_b64_tr_b16 v[76:77], v99 offset:61440
    ds_read_b64_tr_b16 v[78:79], v99 offset:61952
    s_waitcnt lgkmcnt(0)
    v_mfma_f32_16x16x32_bf16 v[84:87], v[72:75], v[40:43], v[84:87]
    v_mfma_f32_16x16x32_bf16 v[84:87], v[76:79], v[44:47], v[84:87]
    s_lshl_b32 s60, s59, 12
    s_lshl_b32 s61, s55, 6
    s_add_u32 s60, s60, s61
    s_add_u32 s60, s60, 1048576
    buffer_store_dwordx4 v[80:83], v100, s[20:23], s60 offen sc1
    s_nop 2
    buffer_store_dwordx4 v[84:87], v100, s[20:23], s60 offen offset:2048 sc1
    s_lshl_b32 s60, s59, 2
    s_add_u32 s60, s60, s55
    s_lshl_b32 s60, s60, 7
    s_add_u32 s60, s60, 2097152
    s_waitcnt vmcnt(0)
    buffer_store_dword v103, v102, s[20:23], s60 offen sc1
    s_branch H_NJ5
H_NF5:
    s_waitcnt vmcnt(0) lgkmcnt(0)
H_NJ5:
    s_barrier
    v_cmp_ne_u32 vcc, s52, v117
    s_cbranch_vccz H_PK6_G
    s_mov_b32 s79, 20000
H_PK6_L:
    s_add_u32 s60, s71, 6
    s_and_b32 s60, s60, 7
    s_lshl_b32 s60, s60, 12
    s_add_u32 s60, s60, s66
    buffer_load_dword v117, v118, s[20:23], s60 offen sc1
    s_waitcnt vmcnt(0)
    v_cmp_ne_u32 vcc, s52, v117
    s_cbranch_vccz H_PK6_G
    s_sub_u32 s79, s79, 1
    s_cmp_eq_u32 s79, 0
    s_cbranch_scc1 H_PK6_G
    s_sleep 4
    s_branch H_PK6_L
H_PK6_G:
    s_add_u32 s60, s71, 7
    s_and_b32 s60, s60, 7
    s_lshl_b32 s60, s60, 12
    s_add_u32 s60, s60, s66
    buffer_load_dword v117, v118, s[20:23], s60 offen sc1
    s_add_u32 s60, s71, 6
    s_and_b32 s60, s60, 7
    s_lshl_b32 s60, s60, 15
    s_add_u32 s60, s60, s58
    s_add_u32 s60, s60, 8388608
    s_add_u32 m0, s58, 131072
    s_nop 0
    buffer_load_dwordx4 v2, s[20:23], s60 offen offset:0 sc1 lds
    buffer_load_dwordx4 v2, s[20:23], s60 offen offset:1024 sc1 lds
    buffer_load_dwordx4 v2, s[20:23], s60 offen offset:2048 sc1 lds
    buffer_load_dwordx4 v2, s[20:23], s60 offen offset:3072 sc1 lds
    s_add_u32 m0, m0, 4096
    s_add_u32 s60, s60, 4096
    buffer_load_dwordx4 v2, s[20:23], s60 offen offset:0 sc1 lds
    buffer_load_dwordx4 v2, s[20:23], s60 offen offset:1024 sc1 lds
    buffer_load_dwordx4 v2, s[20:23], s60 offen offset:2048 sc1 lds
    buffer_load_dwordx4 v2, s[20:23], s60 offen offset:3072 sc1 lds
    s_cmp_eq_u32 s64, 0
    s_cbranch_scc1 H_NF6
    s_mov_b32 s79, 20000
H_PH_L:
    s_lshl_b32 s60, s69, 12
    s_add_u32 s60, s60, 2097152
    buffer_load_dword v11, v104, s[20:23], s60 offen sc1
    s_waitcnt vmcnt(0)
    v_cmp_ne_u32 vcc, s52, v11
    s_cbranch_vccz H_PH_G
    s_sub_u32 s79, s79, 1
    s_cmp_eq_u32 s79, 0
    s_cbranch_scc1 H_PH_G
    s_sleep 4
    s_branch H_PH_L
H_PH_G:
    s_lshl_b32 s60, s69, 1
    s_lshr_b32 s61, s55, 1
    s_add_u32 s60, s60, s61
    s_lshl_b32 s60, s60, 14
    s_and_b32 s61, s55, 1
    s_lshl_b32 s61, s61, 7
    s_add_u32 s60, s60, s61
    s_add_u32 s60, s60, 1048576
    buffer_load_dwordx4 v[16:19], v101, s[20:23], s60 offen sc1
    buffer_load_dwordx4 v[20:23], v101, s[20:23], s60 offen offset:2048 sc1
    s_add_u32 s60, s60, 4096
    buffer_load_dwordx4 v[24:27], v101, s[20:23], s60 offen sc1
    buffer_load_dwordx4 v[28:31], v101, s[20:23], s60 offen offset:2048 sc1
    s_add_u32 s60, s60, 4096
    buffer_load_dwordx4 v[32:35], v101, s[20:23], s60 offen sc1
    buffer_load_dwordx4 v[36:39], v101, s[20:23], s60 offen offset:2048 sc1
    s_add_u32 s60, s60, 4096
    buffer_load_dwordx4 v[40:43], v101, s[20:23], s60 offen sc1
    buffer_load_dwordx4 v[44:47], v101, s[20:23], s60 offen offset:2048 sc1
    s_waitcnt vmcnt(0)
    v_add_f32 v16, v16, v24
    v_add_f32 v17, v17, v25
    v_add_f32 v18, v18, v26
    v_add_f32 v19, v19, v27
    v_add_f32 v20, v20, v28
    v_add_f32 v21, v21, v29
    v_add_f32 v22, v22, v30
    v_add_f32 v23, v23, v31
    v_add_f32 v16, v16, v32
    v_add_f32 v17, v17, v33
    v_add_f32 v18, v18, v34
    v_add_f32 v19, v19, v35
    v_add_f32 v20, v20, v36
    v_add_f32 v21, v21, v37
    v_add_f32 v22, v22, v38
    v_add_f32 v23, v23, v39
    v_add_f32 v16, v16, v40
    v_add_f32 v17, v17, v41
    v_add_f32 v18, v18, v42
    v_add_f32 v19, v19, v43
    v_add_f32 v20, v20, v44
    v_add_f32 v21, v21, v45
    v_add_f32 v22, v22, v46
    v_add_f32 v23, v23, v47
    v_mul_f32 v48, 0xbfb8aa3b, v16
    v_exp_f32 v48, v48
    s_nop 0
    v_add_f32 v48, 1.0, v48
    v_rcp_f32 v48, v48
    v_mul_f32 v49, 0xbfb8aa3b, v17
    v_exp_f32 v49, v49
    s_nop 0
    v_add_f32 v49, 1.0, v49
    v_rcp_f32 v49, v49
    v_mul_f32 v50, 0xbfb8aa3b, v18
    v_exp_f32 v50, v50
    s_nop 0
    v_add_f32 v50, 1.0, v50
    v_rcp_f32 v50, v50
    v_mul_f32 v51, 0xbfb8aa3b, v19
    v_exp_f32 v51, v51
    s_nop 0
    v_add_f32 v51, 1.0, v51
    v_rcp_f32 v51, v51
    v_mul_f32 v16, v16, v20
    v_mul_f32 v16, v16, v48
    v_mul_f32 v17, v17, v21
    v_mul_f32 v17, v17, v49
    v_mul_f32 v18, v18, v22
    v_mul_f32 v18, v18, v50
    v_mul_f32 v19, v19, v23
    v_mul_f32 v19, v19, v51
    v_cvt_pk_bf16_f32 v48, v16, v17
    v_cvt_pk_bf16_f32 v49, v18, v19
    ds_write_b64 v105, v[48:49] offset:0
    s_waitcnt lgkmcnt(0)
    s_branch H_NJ6
H_NF6:
    s_waitcnt vmcnt(0) lgkmcnt(0)
H_NJ6:
    s_and_b32 s60, s4, 7
    s_lshl_b32 s60, s60, 18
    s_lshl_b32 s61, s55, 16
    s_add_u32 s60, s60, s61
    s_lshl_b32 s61, s5, 8
    s_add_u32 s60, s60, s61
    buffer_load_dword v111, v110, s[24:27], s60 offen
    s_barrier
    v_cmp_ne_u32 vcc, s52, v117
    s_cbranch_vccz H_PK7_G
    s_mov_b32 s79, 20000
H_PK7_L:
    s_add_u32 s60, s71, 7
    s_and_b32 s60, s60, 7
    s_lshl_b32 s60, s60, 12
    s_add_u32 s60, s60, s66
    buffer_load_dword v117, v118, s[20:23], s60 offen sc1
    s_waitcnt vmcnt(0)
    v_cmp_ne_u32 vcc, s52, v117
    s_cbranch_vccz H_PK7_G
    s_sub_u32 s79, s79, 1
    s_cmp_eq_u32 s79, 0
    s_cbranch_scc1 H_PK7_G
    s_sleep 4
    s_branch H_PK7_L
H_PK7_G:
    s_add_u32 s60, s71, 7
    s_and_b32 s60, s60, 7
    s_lshl_b32 s60, s60, 15
    s_add_u32 s60, s60, s58
    s_add_u32 s60, s60, 8388608
    s_add_u32 m0, s58, 98304
    s_nop 0
    buffer_load_dwordx4 v2, s[20:23], s60 offen offset:0 sc1 lds
    buffer_load_dwordx4 v2, s[20:23], s60 offen offset:1024 sc1 lds
    buffer_load_dwordx4 v2, s[20:23], s60 offen offset:2048 sc1 lds
    buffer_load_dwordx4 v2, s[20:23], s60 offen offset:3072 sc1 lds
    s_add_u32 m0, m0, 4096
    s_add_u32 s60, s60, 4096
    buffer_load_dwordx4 v2, s[20:23], s60 offen offset:0 sc1 lds
    buffer_load_dwordx4 v2, s[20:23], s60 offen offset:1024 sc1 lds
    buffer_load_dwordx4 v2, s[20:23], s60 offen offset:2048 sc1 lds
    buffer_load_dwordx4 v2, s[20:23], s60 offen offset:3072 sc1 lds
    s_cmp_eq_u32 s64, 0
    s_cbranch_scc1 H_S4N
    ds_read_b128 v[16:19], v113 offset:0
    ds_read_b128 v[20:23], v113 offset:64
    ds_read_b128 v[24:27], v113 offset:128
    ds_read_b128 v[28:31], v113 offset:192
    ds_read_b64_tr_b16 v[48:49], v106 offset:0
    ds_read_b64_tr_b16 v[50:51], v106 offset:1024
    ds_read_b64_tr_b16 v[52:53], v106 offset:8192
    ds_read_b64_tr_b16 v[54:55], v106 offset:9216
    s_waitcnt lgkmcnt(0)
    ds_read_b64_tr_b16 v[56:57], v106 offset:16384
    ds_read_b64_tr_b16 v[58:59], v106 offset:17408
    ds_read_b64_tr_b16 v[60:61], v106 offset:24576
    ds_read_b64_tr_b16 v[62:63], v106 offset:25600
    s_waitcnt lgkmcnt(0)
    ds_read_b64_tr_b16 v[64:65], v106 offset:32
    ds_read_b64_tr_b16 v[66:67], v106 offset:1056
    ds_read_b64_tr_b16 v[68:69], v106 offset:8224
    ds_read_b64_tr_b16 v[70:71], v106 offset:9248
    s_waitcnt lgkmcnt(0)
    ds_read_b64_tr_b16 v[72:73], v106 offset:16416
    ds_read_b64_tr_b16 v[74:75], v106 offset:17440
    ds_read_b64_tr_b16 v[76:77], v106 offset:24608
    ds_read_b64_tr_b16 v[78:79], v106 offset:25632
    s_waitcnt lgkmcnt(0)
    v_mfma_f32_16x16x32_bf16 v[80:83], v[48:51], v[16:19], 0
    v_mfma_f32_16x16x32_bf16 v[80:83], v[52:55], v[20:23], v[80:83]
    v_mfma_f32_16x16x32_bf16 v[80:83], v[56:59], v[24:27], v[80:83]
    v_mfma_f32_16x16x32_bf16 v[80:83], v[60:63], v[28:31], v[80:83]
    v_mfma_f32_16x16x32_bf16 v[84:87], v[64:67], v[16:19], 0
    v_mfma_f32_16x16x32_bf16 v[84:87], v[68:71], v[20:23], v[84:87]
    v_mfma_f32_16x16x32_bf16 v[84:87], v[72:75], v[24:27], v[84:87]
    v_mfma_f32_16x16x32_bf16 v[84:87], v[76:79], v[28:31], v[84:87]
    s_lshl_b32 s60, s69, 15
    s_lshl_b32 s61, s70, 9
    s_add_u32 s60, s60, s61
    s_lshl_b32 s61, s55, 7
    s_add_u32 s60, s60, s61
    s_add_u32 s60, s60, 8781824
    buffer_store_dwordx4 v[80:83], v107, s[20:23], s60 offen sc1
    s_nop 0
    buffer_store_dwordx4 v[84:87], v107, s[20:23], s60 offen offset:64 sc1
    s_lshl_b32 s60, s70, 14
    s_lshl_b32 s61, s69, 2
    s_add_u32 s61, s61, s55
    s_lshl_b32 s61, s61, 7
    s_add_u32 s60, s60, s61
    s_add_u32 s60, s60, 2621440
    s_waitcnt vmcnt(0)
    buffer_store_dword v103, v102, s[20:23], s60 offen sc1
H_S4N:
    s_add_u32 s65, 2, s54
    s_and_b32 s65, s65, 15
    s_lshl_b32 s60, s65, 17
    s_add_u32 m0, s56, 16384
    s_nop 0
    buffer_load_dwordx4 v5, s[24:27], s60 offen lds
    s_add_u32 m0, m0, 1024
    s_add_u32 s60, s60, 8192
    buffer_load_dwordx4 v5, s[24:27], s60 offen lds
    s_add_u32 m0, m0, 1024
    s_add_u32 s60, s60, 8192
    buffer_load_dwordx4 v5, s[24:27], s60 offen lds
    s_add_u32 m0, m0, 1024
    s_add_u32 s60, s60, 8192
    buffer_load_dwordx4 v5, s[24:27], s60 offen lds
    s_add_u32 s65, 4, s54
    s_and_b32 s65, s65, 15
    s_lshl_b32 s60, s65, 17
    s_add_u32 m0, s56, 32768
    s_nop 0
    buffer_load_dwordx4 v5, s[24:27], s60 offen lds
    s_add_u32 m0, m0, 1024
    s_add_u32 s60, s60, 8192
    buffer_load_dwordx4 v5, s[24:27], s60 offen lds
    s_add_u32 m0, m0, 1024
    s_add_u32 s60, s60, 8192
    buffer_load_dwordx4 v5, s[24:27], s60 offen lds
    s_add_u32 m0, m0, 1024
    s_add_u32 s60, s60, 8192
    buffer_load_dwordx4 v5, s[24:27], s60 offen lds
    s_add_u32 s65, 6, s54
    s_and_b32 s65, s65, 15
    s_lshl_b32 s60, s65, 17
    s_add_u32 m0, s56, 49152
    s_nop 0
    buffer_load_dwordx4 v5, s[24:27], s60 offen lds
    s_add_u32 m0, m0, 1024
    s_add_u32 s60, s60, 8192
    buffer_load_dwordx4 v5, s[24:27], s60 offen lds
    s_add_u32 m0, m0, 1024
    s_add_u32 s60, s60, 8192
    buffer_load_dwordx4 v5, s[24:27], s60 offen lds
    s_add_u32 m0, m0, 1024
    s_add_u32 s60, s60, 8192
    buffer_load_dwordx4 v5, s[24:27], s60 offen lds
    s_waitcnt vmcnt(12)
    s_barrier
    s_add_u32 s60, s71, 8
    s_and_b32 s60, s60, 7
    s_lshl_b32 s60, s60, 15
    s_add_u32 s60, s60, s58
    s_add_u32 s60, s60, 8388608
    s_add_u32 m0, s58, 131072
    s_nop 0
    buffer_load_dwordx4 v2, s[20:23], s60 offen offset:0 sc1 lds
    buffer_load_dwordx4 v2, s[20:23], s60 offen offset:1024 sc1 lds
    buffer_load_dwordx4 v2, s[20:23], s60 offen offset:2048 sc1 lds
    buffer_load_dwordx4 v2, s[20:23], s60 offen offset:3072 sc1 lds
    s_add_u32 m0, m0, 4096
    s_add_u32 s60, s60, 4096
    buffer_load_dwordx4 v2, s[20:23], s60 offen offset:0 sc1 lds
    buffer_load_dwordx4 v2, s[20:23], s60 offen offset:1024 sc1 lds
    buffer_load_dwordx4 v2, s[20:23], s60 offen offset:2048 sc1 lds
    buffer_load_dwordx4 v2, s[20:23], s60 offen offset:3072 sc1 lds
    s_add_u32 s65, 0, s54
    s_and_b32 s65, s65, 15
    s_lshl_b32 s60, s65, 17
    s_add_u32 m0, s56, 0
    s_nop 0
    buffer_load_dwordx4 v5, s[24:27], s60 offen lds
    s_add_u32 m0, m0, 1024
    s_add_u32 s60, s60, 8192
    buffer_load_dwordx4 v5, s[24:27], s60 offen lds
    s_add_u32 m0, m0, 1024
    s_add_u32 s60, s60, 8192
    buffer_load_dwordx4 v5, s[24:27], s60 offen lds
    s_add_u32 m0, m0, 1024
    s_add_u32 s60, s60, 8192
    buffer_load_dwordx4 v5, s[24:27], s60 offen lds
    s_add_u32 s65, 8, s54
    s_and_b32 s65, s65, 15
    s_lshl_b32 s60, s65, 17
    s_add_u32 m0, s56, 65536
    s_nop 0
    buffer_load_dwordx4 v5, s[24:27], s60 offen lds
    s_add_u32 m0, m0, 1024
    s_add_u32 s60, s60, 8192
    buffer_load_dwordx4 v5, s[24:27], s60 offen lds
    s_add_u32 m0, m0, 1024
    s_add_u32 s60, s60, 8192
    buffer_load_dwordx4 v5, s[24:27], s60 offen lds
    s_add_u32 m0, m0, 1024
    s_add_u32 s60, s60, 8192
    buffer_load_dwordx4 v5, s[24:27], s60 offen lds
    s_lshl_b32 s62, s55, 1
    s_add_u32 s62, s62, 0
    v_readlane_b32 s63, v10, s62
    v_readlane_b32 s66, v8, s62
    s_lshr_b32 s60, s63, 6
    s_cmp_lg_u32 s60, s4
    s_cbranch_scc1 H_Y0D
    s_mov_b32 s79, 20000
H_PY0_L:
    v_min_u32 v3, 55, v0
    v_lshlrev_b32 v3, 8, v3
    s_lshl_b32 s60, s5, 14
    s_add_u32 s60, s60, 2621440
    buffer_load_dword v12, v3, s[20:23], s60 offen sc1
    buffer_load_dword v13, v3, s[20:23], s60 offen offset:128 sc1
    s_waitcnt vmcnt(0)
    v_xor_b32 v12, s52, v12
    v_xor_b32 v13, s52, v13
    v_or_b32 v12, v12, v13
    v_cmp_ne_u32 vcc, 0, v12
    s_cbranch_vccz H_PY0_G
    s_sub_u32 s79, s79, 1
    s_cmp_eq_u32 s79, 0
    s_cbranch_scc1 H_PY0_G
    s_sleep 4
    s_branch H_PY0_L
H_PY0_G:
    v_and_b32 v3, 31, v0
    v_lshlrev_b32 v3, 4, v3
    v_lshrrev_b32 v4, 5, v0
    v_lshl_add_u32 v4, v4, 15, v3
    s_lshl_b32 s60, s62, 12
    s_lshl_b32 s61, s5, 9
    s_add_u32 s60, s60, s61
    s_add_u32 s60, s60, 8781824
    buffer_load_dwordx4 v[16:19], v4, s[20:23], s60 offen sc1
    s_add_u32 s60, s60, 65536
    buffer_load_dwordx4 v[20:23], v4, s[20:23], s60 offen sc1
    s_add_u32 s60, s60, 65536
    buffer_load_dwordx4 v[24:27], v4, s[20:23], s60 offen sc1
    s_add_u32 s60, s60, 65536
    buffer_load_dwordx4 v[28:31], v4, s[20:23], s60 offen sc1
    s_add_u32 s60, s60, 65536
    buffer_load_dwordx4 v[32:35], v4, s[20:23], s60 offen sc1
    s_add_u32 s60, s60, 65536
    buffer_load_dwordx4 v[36:39], v4, s[20:23], s60 offen sc1
    s_add_u32 s60, s60, 65536
    buffer_load_dwordx4 v[40:43], v4, s[20:23], s60 offen sc1
    s_add_u32 s60, s60, 65536
    buffer_load_dwordx4 v[44:47], v4, s[20:23], s60 offen sc1
    s_add_u32 s60, s60, 65536
    buffer_load_dwordx4 v[48:51], v4, s[20:23], s60 offen sc1
    s_add_u32 s60, s60, 65536
    buffer_load_dwordx4 v[52:55], v4, s[20:23], s60 offen sc1
    s_add_u32 s60, s60, 65536
    buffer_load_dwordx4 v[56:59], v4, s[20:23], s60 offen sc1
    s_add_u32 s60, s60, 65536
    buffer_load_dwordx4 v[60:63], v4, s[20:23], s60 offen sc1
    s_add_u32 s60, s60, 65536
    buffer_load_dwordx4 v[64:67], v4, s[20:23], s60 offen sc1
    s_add_u32 s60, s60, 65536
    buffer_load_dwordx4 v[68:71], v4, s[20:23], s60 offen sc1
    s_lshr_b32 s66, s66, 16
    s_and_b32 s60, s66, 0x7fff
    s_xor_b32 s61, s66, 0xffff
    s_cmp_gt_u32 s66, 0x7fff
    s_cselect_b32 s66, s60, s61
    s_lshl_b32 s66, s66, 16
    v_mov_b32 v12, s66
    v_mul_f32 v12, 0xbfb8aa3b, v12
    v_exp_f32 v12, v12
    s_nop 0
    v_add_f32 v12, 1.0, v12
    v_rcp_f32 v12, v12
    s_waitcnt vmcnt(0)
    v_add_f32 v16, v16, v20
    v_add_f32 v17, v17, v21
    v_add_f32 v18, v18, v22
    v_add_f32 v19, v19, v23
    v_add_f32 v16, v16, v24
    v_add_f32 v17, v17, v25
    v_add_f32 v18, v18, v26
    v_add_f32 v19, v19, v27
    v_add_f32 v16, v16, v28
    v_add_f32 v17, v17, v29
    v_add_f32 v18, v18, v30
    v_add_f32 v19, v19, v31
    v_add_f32 v16, v16, v32
    v_add_f32 v17, v17, v33
    v_add_f32 v18, v18, v34
    v_add_f32 v19, v19, v35
    v_add_f32 v16, v16, v36
    v_add_f32 v17, v17, v37
    v_add_f32 v18, v18, v38
    v_add_f32 v19, v19, v39
    v_add_f32 v16, v16, v40
    v_add_f32 v17, v17, v41
    v_add_f32 v18, v18, v42
    v_add_f32 v19, v19, v43
    v_add_f32 v16, v16, v44
    v_add_f32 v17, v17, v45
    v_add_f32 v18, v18, v46
    v_add_f32 v19, v19, v47
    v_add_f32 v16, v16, v48
    v_add_f32 v17, v17, v49
    v_add_f32 v18, v18, v50
    v_add_f32 v19, v19, v51
    v_add_f32 v16, v16, v52
    v_add_f32 v17, v17, v53
    v_add_f32 v18, v18, v54
    v_add_f32 v19, v19, v55
    v_add_f32 v16, v16, v56
    v_add_f32 v17, v17, v57
    v_add_f32 v18, v18, v58
    v_add_f32 v19, v19, v59
    v_add_f32 v16, v16, v60
    v_add_f32 v17, v17, v61
    v_add_f32 v18, v18, v62
    v_add_f32 v19, v19, v63
    v_add_f32 v16, v16, v64
    v_add_f32 v17, v17, v65
    v_add_f32 v18, v18, v66
    v_add_f32 v19, v19, v67
    v_add_f32 v16, v16, v68
    v_add_f32 v17, v17, v69
    v_add_f32 v18, v18, v70
    v_add_f32 v19, v19, v71
    v_mov_b32 v20, v16
    s_nop 1
    v_permlane32_swap_b32 v16, v20
    v_add_f32 v16, v16, v20
    v_mul_f32 v16, v16, v12
    v_mov_b32 v21, v17
    s_nop 1
    v_permlane32_swap_b32 v17, v21
    v_add_f32 v17, v17, v21
    v_mul_f32 v17, v17, v12
    v_mov_b32 v22, v18
    s_nop 1
    v_permlane32_swap_b32 v18, v22
    v_add_f32 v18, v18, v22
    v_mul_f32 v18, v18, v12
    v_mov_b32 v23, v19
    s_nop 1
    v_permlane32_swap_b32 v19, v23
    v_add_f32 v19, v19, v23
    v_mul_f32 v19, v19, v12
    s_lshl_b32 s60, s62, 9
    s_add_u32 s60, s60, 94208
    v_add_u32 v3, s60, v3
    ds_write_b128 v3, v[16:19]
H_Y0D:
    s_lshl_b32 s62, s55, 1
    s_add_u32 s62, s62, 1
    v_readlane_b32 s63, v10, s62
    v_readlane_b32 s66, v8, s62
    s_lshr_b32 s60, s63, 6
    s_cmp_lg_u32 s60, s4
    s_cbranch_scc1 H_Y1D
    s_mov_b32 s79, 20000
H_PY1_L:
    v_min_u32 v3, 55, v0
    v_lshlrev_b32 v3, 8, v3
    s_lshl_b32 s60, s5, 14
    s_add_u32 s60, s60, 2621440
    buffer_load_dword v12, v3, s[20:23], s60 offen sc1
    buffer_load_dword v13, v3, s[20:23], s60 offen offset:128 sc1
    s_waitcnt vmcnt(0)
    v_xor_b32 v12, s52, v12
    v_xor_b32 v13, s52, v13
    v_or_b32 v12, v12, v13
    v_cmp_ne_u32 vcc, 0, v12
    s_cbranch_vccz H_PY1_G
    s_sub_u32 s79, s79, 1
    s_cmp_eq_u32 s79, 0
    s_cbranch_scc1 H_PY1_G
    s_sleep 4
    s_branch H_PY1_L
H_PY1_G:
    v_and_b32 v3, 31, v0
    v_lshlrev_b32 v3, 4, v3
    v_lshrrev_b32 v4, 5, v0
    v_lshl_add_u32 v4, v4, 15, v3
    s_lshl_b32 s60, s62, 12
    s_lshl_b32 s61, s5, 9
    s_add_u32 s60, s60, s61
    s_add_u32 s60, s60, 8781824
    buffer_load_dwordx4 v[16:19], v4, s[20:23], s60 offen sc1
    s_add_u32 s60, s60, 65536
    buffer_load_dwordx4 v[20:23], v4, s[20:23], s60 offen sc1
    s_add_u32 s60, s60, 65536
    buffer_load_dwordx4 v[24:27], v4, s[20:23], s60 offen sc1
    s_add_u32 s60, s60, 65536
    buffer_load_dwordx4 v[28:31], v4, s[20:23], s60 offen sc1
    s_add_u32 s60, s60, 65536
    buffer_load_dwordx4 v[32:35], v4, s[20:23], s60 offen sc1
    s_add_u32 s60, s60, 65536
    buffer_load_dwordx4 v[36:39], v4, s[20:23], s60 offen sc1
    s_add_u32 s60, s60, 65536
    buffer_load_dwordx4 v[40:43], v4, s[20:23], s60 offen sc1
    s_add_u32 s60, s60, 65536
    buffer_load_dwordx4 v[44:47], v4, s[20:23], s60 offen sc1
    s_add_u32 s60, s60, 65536
    buffer_load_dwordx4 v[48:51], v4, s[20:23], s60 offen sc1
    s_add_u32 s60, s60, 65536
    buffer_load_dwordx4 v[52:55], v4, s[20:23], s60 offen sc1
    s_add_u32 s60, s60, 65536
    buffer_load_dwordx4 v[56:59], v4, s[20:23], s60 offen sc1
    s_add_u32 s60, s60, 65536
    buffer_load_dwordx4 v[60:63], v4, s[20:23], s60 offen sc1
    s_add_u32 s60, s60, 65536
    buffer_load_dwordx4 v[64:67], v4, s[20:23], s60 offen sc1
    s_add_u32 s60, s60, 65536
    buffer_load_dwordx4 v[68:71], v4, s[20:23], s60 offen sc1
    s_lshr_b32 s66, s66, 16
    s_and_b32 s60, s66, 0x7fff
    s_xor_b32 s61, s66, 0xffff
    s_cmp_gt_u32 s66, 0x7fff
    s_cselect_b32 s66, s60, s61
    s_lshl_b32 s66, s66, 16
    v_mov_b32 v12, s66
    v_mul_f32 v12, 0xbfb8aa3b, v12
    v_exp_f32 v12, v12
    s_nop 0
    v_add_f32 v12, 1.0, v12
    v_rcp_f32 v12, v12
    s_waitcnt vmcnt(0)
    v_add_f32 v16, v16, v20
    v_add_f32 v17, v17, v21
    v_add_f32 v18, v18, v22
    v_add_f32 v19, v19, v23
    v_add_f32 v16, v16, v24
    v_add_f32 v17, v17, v25
    v_add_f32 v18, v18, v26
    v_add_f32 v19, v19, v27
    v_add_f32 v16, v16, v28
    v_add_f32 v17, v17, v29
    v_add_f32 v18, v18, v30
    v_add_f32 v19, v19, v31
    v_add_f32 v16, v16, v32
    v_add_f32 v17, v17, v33
    v_add_f32 v18, v18, v34
    v_add_f32 v19, v19, v35
    v_add_f32 v16, v16, v36
    v_add_f32 v17, v17, v37
    v_add_f32 v18, v18, v38
    v_add_f32 v19, v19, v39
    v_add_f32 v16, v16, v40
    v_add_f32 v17, v17, v41
    v_add_f32 v18, v18, v42
    v_add_f32 v19, v19, v43
    v_add_f32 v16, v16, v44
    v_add_f32 v17, v17, v45
    v_add_f32 v18, v18, v46
    v_add_f32 v19, v19, v47
    v_add_f32 v16, v16, v48
    v_add_f32 v17, v17, v49
    v_add_f32 v18, v18, v50
    v_add_f32 v19, v19, v51
    v_add_f32 v16, v16, v52
    v_add_f32 v17, v17, v53
    v_add_f32 v18, v18, v54
    v_add_f32 v19, v19, v55
    v_add_f32 v16, v16, v56
    v_add_f32 v17, v17, v57
    v_add_f32 v18, v18, v58
    v_add_f32 v19, v19, v59
    v_add_f32 v16, v16, v60
    v_add_f32 v17, v17, v61
    v_add_f32 v18, v18, v62
    v_add_f32 v19, v19, v63
    v_add_f32 v16, v16, v64
    v_add_f32 v17, v17, v65
    v_add_f32 v18, v18, v66
    v_add_f32 v19, v19, v67
    v_add_f32 v16, v16, v68
    v_add_f32 v17, v17, v69
    v_add_f32 v18, v18, v70
    v_add_f32 v19, v19, v71
    v_mov_b32 v20, v16
    s_nop 1
    v_permlane32_swap_b32 v16, v20
    v_add_f32 v16, v16, v20
    v_mul_f32 v16, v16, v12
    v_mov_b32 v21, v17
    s_nop 1
    v_permlane32_swap_b32 v17, v21
    v_add_f32 v17, v17, v21
    v_mul_f32 v17, v17, v12
    v_mov_b32 v22, v18
    s_nop 1
    v_permlane32_swap_b32 v18, v22
    v_add_f32 v18, v18, v22
    v_mul_f32 v18, v18, v12
    v_mov_b32 v23, v19
    s_nop 1
    v_permlane32_swap_b32 v19, v23
    v_add_f32 v19, v19, v23
    v_mul_f32 v19, v19, v12
    s_lshl_b32 s60, s62, 9
    s_add_u32 s60, s60, 94208
    v_add_u32 v3, s60, v3
    ds_write_b128 v3, v[16:19]
H_Y1D:
    s_waitcnt vmcnt(8) lgkmcnt(0)
    s_barrier
    s_add_u32 s60, s71, 9
    s_and_b32 s60, s60, 7
    s_lshl_b32 s60, s60, 15
    s_add_u32 s60, s60, s58
    s_add_u32 s60, s60, 8388608
    s_add_u32 m0, s58, 98304
    s_nop 0
    buffer_load_dwordx4 v2, s[20:23], s60 offen offset:0 sc1 lds
    buffer_load_dwordx4 v2, s[20:23], s60 offen offset:1024 sc1 lds
    buffer_load_dwordx4 v2, s[20:23], s60 offen offset:2048 sc1 lds
    buffer_load_dwordx4 v2, s[20:23], s60 offen offset:3072 sc1 lds
    s_add_u32 m0, m0, 4096
    s_add_u32 s60, s60, 4096
    buffer_load_dwordx4 v2, s[20:23], s60 offen offset:0 sc1 lds
    buffer_load_dwordx4 v2, s[20:23], s60 offen offset:1024 sc1 lds
    buffer_load_dwordx4 v2, s[20:23], s60 offen offset:2048 sc1 lds
    buffer_load_dwordx4 v2, s[20:23], s60 offen offset:3072 sc1 lds
    s_lshl_b32 s60, s4, 1
    s_lshr_b32 s61, s55, 1
    s_add_u32 s60, s60, s61
    s_lshl_b32 s60, s60, 16
    s_and_b32 s61, s55, 1
    s_lshl_b32 s61, s61, 11
    s_add_u32 s60, s60, s61
    s_add_u32 s60, s60, 4194304
    v_add_u32 v6, s60, v2
    s_lshl_b32 s57, s55, 11
    s_lshl_b32 s77, s4, 6
    s_and_b32 s60, s55, 1
    s_lshl_b32 s60, s60, 1
    s_add_u32 s77, s77, s60
    s_lshr_b32 s60, s55, 1
    s_add_u32 s77, s77, s60
    s_lshl_b32 s77, s77, 7
    s_add_u32 s77, s77, 2359296
    v_and_b32 v114, 7, v0
    v_lshlrev_b32 v114, 10, v114
    s_mov_b64 s[72:73], 0xff
    s_lshl_b32 s74, 1, s5
    s_xor_b32 s74, s74, 0xff
    s_mov_b32 s75, 0
    s_cmp_lg_u32 s55, 3
    s_cbranch_scc1 H_G1
    s_lshl_b32 s60, s4, 8
    s_add_u32 s60, s60, 8650752
    buffer_load_dword v12, v108, s[20:23], s60 offen sc1
    s_lshl_b32 s60, s4, 6
    v_add_u32 v13, s60, v0
    v_mov_b32 v14, -1
    v_readlane_b32 s60, v10, 0
    s_nop 1
    v_cmp_eq_u32 vcc, s60, v13
    s_nop 1
    v_cndmask_b32 v14, v14, 0, vcc
    v_readlane_b32 s60, v10, 1
    s_nop 1
    v_cmp_eq_u32 vcc, s60, v13
    s_nop 1
    v_cndmask_b32 v14, v14, 1, vcc
    v_readlane_b32 s60, v10, 2
    s_nop 1
    v_cmp_eq_u32 vcc, s60, v13
    s_nop 1
    v_cndmask_b32 v14, v14, 2, vcc
    v_readlane_b32 s60, v10, 3
    s_nop 1
    v_cmp_eq_u32 vcc, s60, v13
    s_nop 1
    v_cndmask_b32 v14, v14, 3, vcc
    v_readlane_b32 s60, v10, 4
    s_nop 1
    v_cmp_eq_u32 vcc, s60, v13
    s_nop 1
    v_cndmask_b32 v14, v14, 4, vcc
    v_readlane_b32 s60, v10, 5
    s_nop 1
    v_cmp_eq_u32 vcc, s60, v13
    s_nop 1
    v_cndmask_b32 v14, v14, 5, vcc
    v_readlane_b32 s60, v10, 6
    s_nop 1
    v_cmp_eq_u32 vcc, s60, v13
    s_nop 1
    v_cndmask_b32 v14, v14, 6, vcc
    v_readlane_b32 s60, v10, 7
    s_nop 1
    v_cmp_eq_u32 vcc, s60, v13
    s_nop 1
    v_cndmask_b32 v14, v14, 7, vcc
    v_add_u32 v13, 93696, v108
    s_waitcnt vmcnt(0)
    ds_write_b32 v13, v12
    ds_write_b32 v13, v14 offset:256
H_G1:
    s_waitcnt vmcnt(0) lgkmcnt(0)
    s_barrier
    s_cmp_lg_u32 s55, 0
    s_cbranch_scc1 H_K8
    s_add_u32 s60, s71, 10
    s_and_b32 s60, s60, 7
    s_lshl_b32 s60, s60, 15
    s_add_u32 s60, s60, s58
    s_add_u32 s60, s60, 8388608
    s_add_u32 m0, s58, 131072
    s_nop 0
    buffer_load_dwordx4 v2, s[20:23], s60 offen offset:0 sc1 lds
    buffer_load_dwordx4 v2, s[20:23], s60 offen offset:1024 sc1 lds
    buffer_load_dwordx4 v2, s[20:23], s60 offen offset:2048 sc1 lds
    buffer_load_dwordx4 v2, s[20:23], s60 offen offset:3072 sc1 lds
    s_add_u32 m0, m0, 4096
    s_add_u32 s60, s60, 4096
    buffer_load_dwordx4 v2, s[20:23], s60 offen offset:0 sc1 lds
    buffer_load_dwordx4 v2, s[20:23], s60 offen offset:1024 sc1 lds
    buffer_load_dwordx4 v2, s[20:23], s60 offen offset:2048 sc1 lds
    buffer_load_dwordx4 v2, s[20:23], s60 offen offset:3072 sc1 lds
H_K8:
    s_add_u32 s65, 10, s54
    s_and_b32 s65, s65, 15
    s_lshl_b32 s60, s65, 17
    s_add_u32 m0, s56, 147456
    s_nop 0
    buffer_load_dwordx4 v5, s[24:27], s60 offen lds
    s_add_u32 m0, m0, 1024
    s_add_u32 s60, s60, 8192
    buffer_load_dwordx4 v5, s[24:27], s60 offen lds
    s_add_u32 m0, m0, 1024
    s_add_u32 s60, s60, 8192
    buffer_load_dwordx4 v5, s[24:27], s60 offen lds
    s_add_u32 m0, m0, 1024
    s_add_u32 s60, s60, 8192
    buffer_load_dwordx4 v5, s[24:27], s60 offen lds
    s_waitcnt vmcnt(0)
    s_barrier
    s_mov_b32 s79, 80000
    buffer_load_dword v11, v114, s[20:23], s77 offen sc1
    buffer_load_dword v12, v114, s[20:23], s77 offen sc1
H_PD_L:
    buffer_load_dword v13, v114, s[20:23], s77 offen sc1
    s_waitcnt vmcnt(2)
    v_cmp_ne_u32 vcc, s52, v11
    s_nop 0
    s_and_b64 vcc, vcc, s[72:73]
    s_cbranch_vccz H_PD_G
    buffer_load_dword v11, v114, s[20:23], s77 offen sc1
    s_waitcnt vmcnt(2)
    v_cmp_ne_u32 vcc, s52, v12
    s_nop 0
    s_and_b64 vcc, vcc, s[72:73]
    s_cbranch_vccz H_PD_G
    buffer_load_dword v12, v114, s[20:23], s77 offen sc1
    s_waitcnt vmcnt(2)
    v_cmp_ne_u32 vcc, s52, v13
    s_nop 0
    s_and_b64 vcc, vcc, s[72:73]
    s_cbranch_vccz H_PD_G
    s_sub_u32 s79, s79, 1
    s_cbranch_scc0 H_PD_L
H_PD_G:
    s_add_u32 s77, s77, 512
    s_add_u32 s65, 0, s54
    s_and_b32 s65, s65, 15
    s_lshl_b32 s60, s65, 12
    s_add_u32 m0, s57, 81920
    s_nop 0
    buffer_load_dwordx4 v6, s[20:23], s60 offen sc1 lds
    buffer_load_dwordx4 v6, s[20:23], s60 offen offset:1024 sc1 lds
    s_add_u32 s65, 2, s54
    s_and_b32 s65, s65, 15
    s_lshl_b32 s60, s65, 12
    s_add_u32 m0, s57, 98304
    s_nop 0
    buffer_load_dwordx4 v6, s[20:23], s60 offen sc1 lds
    buffer_load_dwordx4 v6, s[20:23], s60 offen offset:1024 sc1 lds
    s_add_u32 s65, 4, s54
    s_and_b32 s65, s65, 15
    s_lshl_b32 s60, s65, 12
    s_add_u32 m0, s57, 106496
    s_nop 0
    buffer_load_dwordx4 v6, s[20:23], s60 offen sc1 lds
    buffer_load_dwordx4 v6, s[20:23], s60 offen offset:1024 sc1 lds
    s_add_u32 s65, 6, s54
    s_and_b32 s65, s65, 15
    s_lshl_b32 s60, s65, 12
    s_add_u32 m0, s57, 114688
    s_nop 0
    buffer_load_dwordx4 v6, s[20:23], s60 offen sc1 lds
    buffer_load_dwordx4 v6, s[20:23], s60 offen offset:1024 sc1 lds
    s_waitcnt vmcnt(4)
    s_barrier
    s_add_u32 s65, 8, s54
    s_and_b32 s65, s65, 15
    s_lshl_b32 s60, s65, 12
    s_add_u32 m0, s57, 131072
    s_nop 0
    buffer_load_dwordx4 v6, s[20:23], s60 offen sc1 lds
    buffer_load_dwordx4 v6, s[20:23], s60 offen offset:1024 sc1 lds
    s_add_u32 s65, 10, s54
    s_and_b32 s65, s65, 15
    s_lshl_b32 s60, s65, 12
    s_add_u32 m0, s57, 139264
    s_nop 0
    buffer_load_dwordx4 v6, s[20:23], s60 offen sc1 lds
    buffer_load_dwordx4 v6, s[20:23], s60 offen offset:1024 sc1 lds
    s_waitcnt vmcnt(6)
    s_barrier
    s_add_u32 s65, 12, s54
    s_and_b32 s65, s65, 15
    s_lshl_b32 s60, s65, 12
    s_add_u32 m0, s57, 81920
    s_nop 0
    buffer_load_dwordx4 v6, s[20:23], s60 offen sc1 lds
    buffer_load_dwordx4 v6, s[20:23], s60 offen offset:1024 sc1 lds
    s_add_u32 s65, 12, s54
    s_and_b32 s65, s65, 15
    s_lshl_b32 s60, s65, 17
    s_add_u32 m0, s56, 0
    s_nop 0
    buffer_load_dwordx4 v5, s[24:27], s60 offen lds
    s_add_u32 m0, m0, 1024
    s_add_u32 s60, s60, 8192
    buffer_load_dwordx4 v5, s[24:27], s60 offen lds
    s_add_u32 m0, m0, 1024
    s_add_u32 s60, s60, 8192
    buffer_load_dwordx4 v5, s[24:27], s60 offen lds
    s_add_u32 m0, m0, 1024
    s_add_u32 s60, s60, 8192
    buffer_load_dwordx4 v5, s[24:27], s60 offen lds
    s_waitcnt vmcnt(10)
    s_barrier
    s_add_u32 s65, 14, s54
    s_and_b32 s65, s65, 15
    s_lshl_b32 s60, s65, 12
    s_add_u32 m0, s57, 98304
    s_nop 0
    buffer_load_dwordx4 v6, s[20:23], s60 offen sc1 lds
    buffer_load_dwordx4 v6, s[20:23], s60 offen offset:1024 sc1 lds
    s_add_u32 s65, 14, s54
    s_and_b32 s65, s65, 15
    s_lshl_b32 s60, s65, 17
    s_add_u32 m0, s56, 16384
    s_nop 0
    buffer_load_dwordx4 v5, s[24:27], s60 offen lds
    s_add_u32 m0, m0, 1024
    s_add_u32 s60, s60, 8192
    buffer_load_dwordx4 v5, s[24:27], s60 offen lds
    s_add_u32 m0, m0, 1024
    s_add_u32 s60, s60, 8192
    buffer_load_dwordx4 v5, s[24:27], s60 offen lds
    s_add_u32 m0, m0, 1024
    s_add_u32 s60, s60, 8192
    buffer_load_dwordx4 v5, s[24:27], s60 offen lds
    s_waitcnt vmcnt(14)
    s_barrier
    s_add_u32 s65, 1, s54
    s_and_b32 s65, s65, 15
    s_lshl_b32 s60, s65, 17
    s_add_u32 m0, s56, 32768
    s_nop 0
    buffer_load_dwordx4 v5, s[24:27], s60 offen lds
    s_add_u32 m0, m0, 1024
    s_add_u32 s60, s60, 8192
    buffer_load_dwordx4 v5, s[24:27], s60 offen lds
    s_add_u32 m0, m0, 1024
    s_add_u32 s60, s60, 8192
    buffer_load_dwordx4 v5, s[24:27], s60 offen lds
    s_add_u32 m0, m0, 1024
    s_add_u32 s60, s60, 8192
    buffer_load_dwordx4 v5, s[24:27], s60 offen lds
    s_waitcnt vmcnt(16)
    s_barrier
    s_add_u32 s65, 3, s54
    s_and_b32 s65, s65, 15
    s_lshl_b32 s60, s65, 17
    s_add_u32 m0, s56, 49152
    s_nop 0
    buffer_load_dwordx4 v5, s[24:27], s60 offen lds
    s_add_u32 m0, m0, 1024
    s_add_u32 s60, s60, 8192
    buffer_load_dwordx4 v5, s[24:27], s60 offen lds
    s_add_u32 m0, m0, 1024
    s_add_u32 s60, s60, 8192
    buffer_load_dwordx4 v5, s[24:27], s60 offen lds
    s_add_u32 m0, m0, 1024
    s_add_u32 s60, s60, 8192
    buffer_load_dwordx4 v5, s[24:27], s60 offen lds
    buffer_load_dword v11, v114, s[20:23], s77 offen sc1
    s_waitcnt vmcnt(15)
    s_barrier
    s_add_u32 s65, 5, s54
    s_and_b32 s65, s65, 15
    s_lshl_b32 s60, s65, 17
    s_add_u32 m0, s56, 65536
    s_nop 0
    buffer_load_dwordx4 v5, s[24:27], s60 offen lds
    s_add_u32 m0, m0, 1024
    s_add_u32 s60, s60, 8192
    buffer_load_dwordx4 v5, s[24:27], s60 offen lds
    s_add_u32 m0, m0, 1024
    s_add_u32 s60, s60, 8192
    buffer_load_dwordx4 v5, s[24:27], s60 offen lds
    s_add_u32 m0, m0, 1024
    s_add_u32 s60, s60, 8192
    buffer_load_dwordx4 v5, s[24:27], s60 offen lds
    s_waitcnt vmcnt(4)
    s_barrier
    v_cmp_ne_u32 vcc, s52, v11
    s_nop 0
    s_and_b64 vcc, vcc, s[74:75]
    s_cbranch_vccnz H_SLOWB
    s_add_u32 s65, 7, s54
    s_and_b32 s65, s65, 15
    s_lshl_b32 s60, s65, 17
    s_add_u32 m0, s56, 147456
    s_nop 0
    buffer_load_dwordx4 v5, s[24:27], s60 offen lds
    s_add_u32 m0, m0, 1024
    s_add_u32 s60, s60, 8192
    buffer_load_dwordx4 v5, s[24:27], s60 offen lds
    s_add_u32 m0, m0, 1024
    s_add_u32 s60, s60, 8192
    buffer_load_dwordx4 v5, s[24:27], s60 offen lds
    s_add_u32 m0, m0, 1024
    s_add_u32 s60, s60, 8192
    buffer_load_dwordx4 v5, s[24:27], s60 offen lds
    s_add_u32 s65, 3, s54
    s_and_b32 s65, s65, 15
    s_lshl_b32 s60, s65, 12
    s_add_u32 m0, s57, 106496
    s_nop 0
    buffer_load_dwordx4 v6, s[20:23], s60 offen sc1 lds
    buffer_load_dwordx4 v6, s[20:23], s60 offen offset:1024 sc1 lds
    s_add_u32 s65, 5, s54
    s_and_b32 s65, s65, 15
    s_lshl_b32 s60, s65, 12
    s_add_u32 m0, s57, 114688
    s_nop 0
    buffer_load_dwordx4 v6, s[20:23], s60 offen sc1 lds
    buffer_load_dwordx4 v6, s[20:23], s60 offen offset:1024 sc1 lds
    s_add_u32 s65, 7, s54
    s_and_b32 s65, s65, 15
    s_lshl_b32 s60, s65, 12
    s_add_u32 m0, s57, 131072
    s_nop 0
    buffer_load_dwordx4 v6, s[20:23], s60 offen sc1 lds
    buffer_load_dwordx4 v6, s[20:23], s60 offen offset:1024 sc1 lds
    s_add_u32 s65, 9, s54
    s_and_b32 s65, s65, 15
    s_lshl_b32 s60, s65, 12
    s_add_u32 m0, s57, 139264
    s_nop 0
    buffer_load_dwordx4 v6, s[20:23], s60 offen sc1 lds
    buffer_load_dwordx4 v6, s[20:23], s60 offen offset:1024 sc1 lds
    s_waitcnt vmcnt(16)
    s_barrier
    s_add_u32 s65, 11, s54
    s_and_b32 s65, s65, 15
    s_lshl_b32 s60, s65, 12
    s_add_u32 m0, s57, 81920
    s_nop 0
    buffer_load_dwordx4 v6, s[20:23], s60 offen sc1 lds
    buffer_load_dwordx4 v6, s[20:23], s60 offen offset:1024 sc1 lds
    s_add_u32 s65, 9, s54
    s_and_b32 s65, s65, 15
    s_lshl_b32 s60, s65, 17
    s_add_u32 m0, s56, 0
    s_nop 0
    buffer_load_dwordx4 v5, s[24:27], s60 offen lds
    s_add_u32 m0, m0, 1024
    s_add_u32 s60, s60, 8192
    buffer_load_dwordx4 v5, s[24:27], s60 offen lds
    s_add_u32 m0, m0, 1024
    s_add_u32 s60, s60, 8192
    buffer_load_dwordx4 v5, s[24:27], s60 offen lds
    s_add_u32 m0, m0, 1024
    s_add_u32 s60, s60, 8192
    buffer_load_dwordx4 v5, s[24:27], s60 offen lds
    s_branch H_BJ
H_SLOWB:
    buffer_load_dword v11, v114, s[20:23], s77 offen sc1
    s_add_u32 s65, 7, s54
    s_and_b32 s65, s65, 15
    s_lshl_b32 s60, s65, 17
    s_add_u32 m0, s56, 147456
    s_nop 0
    buffer_load_dwordx4 v5, s[24:27], s60 offen lds
    s_add_u32 m0, m0, 1024
    s_add_u32 s60, s60, 8192
    buffer_load_dwordx4 v5, s[24:27], s60 offen lds
    s_add_u32 m0, m0, 1024
    s_add_u32 s60, s60, 8192
    buffer_load_dwordx4 v5, s[24:27], s60 offen lds
    s_add_u32 m0, m0, 1024
    s_add_u32 s60, s60, 8192
    buffer_load_dwordx4 v5, s[24:27], s60 offen lds
    s_waitcnt vmcnt(9)
    s_barrier
    s_waitcnt vmcnt(4)
    v_cmp_ne_u32 vcc, s52, v11
    s_nop 0
    s_and_b64 vcc, vcc, s[74:75]
    s_cbranch_vccz H_PE_G
    s_mov_b32 s79, 80000
    buffer_load_dword v11, v114, s[20:23], s77 offen sc1
    buffer_load_dword v12, v114, s[20:23], s77 offen sc1
H_PE_L:
    buffer_load_dword v13, v114, s[20:23], s77 offen sc1
    s_waitcnt vmcnt(2)
    v_cmp_ne_u32 vcc, s52, v11
    s_nop 0
    s_and_b64 vcc, vcc, s[74:75]
    s_cbranch_vccz H_PE_G
    buffer_load_dword v11, v114, s[20:23], s77 offen sc1
    s_waitcnt vmcnt(2)
    v_cmp_ne_u32 vcc, s52, v12
    s_nop 0
    s_and_b64 vcc, vcc, s[74:75]
    s_cbranch_vccz H_PE_G
    buffer_load_dword v12, v114, s[20:23], s77 offen sc1
    s_waitcnt vmcnt(2)
    v_cmp_ne_u32 vcc, s52, v13
    s_nop 0
    s_and_b64 vcc, vcc, s[74:75]
    s_cbranch_vccz H_PE_G
    s_sub_u32 s79, s79, 1
    s_cbranch_scc0 H_PE_L
H_PE_G:
    s_add_u32 s65, 3, s54
    s_and_b32 s65, s65, 15
    s_lshl_b32 s60, s65, 12
    s_add_u32 m0, s57, 106496
    s_nop 0
    buffer_load_dwordx4 v6, s[20:23], s60 offen sc1 lds
    buffer_load_dwordx4 v6, s[20:23], s60 offen offset:1024 sc1 lds
    s_add_u32 s65, 5, s54
    s_and_b32 s65, s65, 15
    s_lshl_b32 s60, s65, 12
    s_add_u32 m0, s57, 114688
    s_nop 0
    buffer_load_dwordx4 v6, s[20:23], s60 offen sc1 lds
    buffer_load_dwordx4 v6, s[20:23], s60 offen offset:1024 sc1 lds
    s_add_u32 s65, 7, s54
    s_and_b32 s65, s65, 15
    s_lshl_b32 s60, s65, 12
    s_add_u32 m0, s57, 131072
    s_nop 0
    buffer_load_dwordx4 v6, s[20:23], s60 offen sc1 lds
    buffer_load_dwordx4 v6, s[20:23], s60 offen offset:1024 sc1 lds
    s_add_u32 s65, 9, s54
    s_and_b32 s65, s65, 15
    s_lshl_b32 s60, s65, 12
    s_add_u32 m0, s57, 139264
    s_nop 0
    buffer_load_dwordx4 v6, s[20:23], s60 offen sc1 lds
    buffer_load_dwordx4 v6, s[20:23], s60 offen offset:1024 sc1 lds
    s_add_u32 s65, 11, s54
    s_and_b32 s65, s65, 15
    s_lshl_b32 s60, s65, 12
    s_add_u32 m0, s57, 81920
    s_nop 0
    buffer_load_dwordx4 v6, s[20:23], s60 offen sc1 lds
    buffer_load_dwordx4 v6, s[20:23], s60 offen offset:1024 sc1 lds
    s_add_u32 s65, 9, s54
    s_and_b32 s65, s65, 15
    s_lshl_b32 s60, s65, 17
    s_add_u32 m0, s56, 0
    s_nop 0
    buffer_load_dwordx4 v5, s[24:27], s60 offen lds
    s_add_u32 m0, m0, 1024
    s_add_u32 s60, s60, 8192
    buffer_load_dwordx4 v5, s[24:27], s60 offen lds
    s_add_u32 m0, m0, 1024
    s_add_u32 s60, s60, 8192
    buffer_load_dwordx4 v5, s[24:27], s60 offen lds
    s_add_u32 m0, m0, 1024
    s_add_u32 s60, s60, 8192
    buffer_load_dwordx4 v5, s[24:27], s60 offen lds
H_BJ:
    s_waitcnt vmcnt(12)
    s_barrier
    s_add_u32 s65, 13, s54
    s_and_b32 s65, s65, 15
    s_lshl_b32 s60, s65, 12
    s_add_u32 m0, s57, 98304
    s_nop 0
    buffer_load_dwordx4 v6, s[20:23], s60 offen sc1 lds
    buffer_load_dwordx4 v6, s[20:23], s60 offen offset:1024 sc1 lds
    s_add_u32 s65, 15, s54
    s_and_b32 s65, s65, 15
    s_lshl_b32 s60, s65, 12
    s_add_u32 m0, s57, 122880
    s_nop 0
    buffer_load_dwordx4 v6, s[20:23], s60 offen sc1 lds
    buffer_load_dwordx4 v6, s[20:23], s60 offen offset:1024 sc1 lds
    s_add_u32 s65, 11, s54
    s_and_b32 s65, s65, 15
    s_lshl_b32 s60, s65, 17
    s_add_u32 m0, s56, 16384
    s_nop 0
    buffer_load_dwordx4 v5, s[24:27], s60 offen lds
    s_add_u32 m0, m0, 1024
    s_add_u32 s60, s60, 8192
    buffer_load_dwordx4 v5, s[24:27], s60 offen lds
    s_add_u32 m0, m0, 1024
    s_add_u32 s60, s60, 8192
    buffer_load_dwordx4 v5, s[24:27], s60 offen lds
    s_add_u32 m0, m0, 1024
    s_add_u32 s60, s60, 8192
    buffer_load_dwordx4 v5, s[24:27], s60 offen lds
    s_add_u32 s65, 13, s54
    s_and_b32 s65, s65, 15
    s_lshl_b32 s60, s65, 17
    s_add_u32 m0, s56, 32768
    s_nop 0
    buffer_load_dwordx4 v5, s[24:27], s60 offen lds
    s_add_u32 m0, m0, 1024
    s_add_u32 s60, s60, 8192
    buffer_load_dwordx4 v5, s[24:27], s60 offen lds
    s_add_u32 m0, m0, 1024
    s_add_u32 s60, s60, 8192
    buffer_load_dwordx4 v5, s[24:27], s60 offen lds
    s_add_u32 m0, m0, 1024
    s_add_u32 s60, s60, 8192
    buffer_load_dwordx4 v5, s[24:27], s60 offen lds
    s_waitcnt vmcnt(22)
    s_barrier
    s_waitcnt vmcnt(20)
    s_barrier
    s_add_u32 s65, 15, s54
    s_and_b32 s65, s65, 15
    s_lshl_b32 s60, s65, 17
    s_add_u32 m0, s56, 49152
    s_nop 0
    buffer_load_dwordx4 v5, s[24:27], s60 offen lds
    s_add_u32 m0, m0, 1024
    s_add_u32 s60, s60, 8192
    buffer_load_dwordx4 v5, s[24:27], s60 offen lds
    s_add_u32 m0, m0, 1024
    s_add_u32 s60, s60, 8192
    buffer_load_dwordx4 v5, s[24:27], s60 offen lds
    s_add_u32 m0, m0, 1024
    s_add_u32 s60, s60, 8192
    buffer_load_dwordx4 v5, s[24:27], s60 offen lds
    s_waitcnt vmcnt(16)
    s_barrier
    s_waitcnt vmcnt(8)
    s_barrier
    s_waitcnt vmcnt(4)
    s_barrier
    s_waitcnt vmcnt(0)
    s_barrier
L_END:
    s_endpgm
L_CODE_END:
.section .rodata,"a"
.p2align 6
.amdhsa_kernel gated_mix__grouped_kv_mqa__moe_arch_mod__prompt_kernel
  .amdhsa_next_free_vgpr 168
  .amdhsa_next_free_sgpr 102
  .amdhsa_accum_offset 168
  .amdhsa_group_segment_fixed_size 0
  .amdhsa_kernarg_size 112
  .amdhsa_user_sgpr_count 2
  .amdhsa_user_sgpr_kernarg_segment_ptr 1
  .amdhsa_system_sgpr_workgroup_id_x 1
.end_amdhsa_kernel
```
